```python
import torch

def _softmax(x, axis=-1):
    return torch.softmax(x, dim=axis)
def _gelu(x):
    return torch.nn.functional.gelu(x, approximate="tanh")
def _silu(x):
    return torch.nn.functional.silu(x)
def _sigmoid(x):
    return torch.sigmoid(x)
def _layernorm(x, axis=-1, eps=1e-5):
    m = x.mean(dim=axis, keepdim=True)
    v = x.var(dim=axis, keepdim=True, unbiased=False)
    return (x - m) / torch.sqrt(v + eps)
def _scatter_add(tgt, idx, src, axis=0):
    return tgt.clone().index_add_(axis, idx, src)
def _segment_sum(src, seg, n):
    out = torch.zeros((n,) + src.shape[1:], dtype=src.dtype)
    return out.index_add_(0, seg, src)
def _pad(x, pw):
    flat = tuple(v for pair in reversed(pw) for v in pair)
    return torch.nn.functional.pad(x, flat)

kernel_name = 'recurrent_scan__ssm_conv_s5__mixer_channel_mlp__prompt'

def setup_inputs():

    _w = (lambda a: (lambda t: t.to(torch.bfloat16) if t.is_floating_point() else t)(torch.as_tensor(a)))
    def _A_setup():
        B, S, D = 1, 2048, 448
        P = D
        Lambda_re = -0.5 * (lambda _x: torch.exp(torch.as_tensor(_x)))((lambda *s: torch.randn(*s, dtype=torch.bfloat16) * 0.4)(P))
        Lambda_im = (lambda *s: torch.randn(*s, dtype=torch.bfloat16) * 0.4)(P) * 1.0
        B_re = (lambda *s: torch.randn(*s, dtype=torch.bfloat16) * 0.4)(P, D) * (D ** -0.5)
        B_im = (lambda *s: torch.randn(*s, dtype=torch.bfloat16) * 0.4)(P, D) * (D ** -0.5)
        C_re = (lambda *s: torch.randn(*s, dtype=torch.bfloat16) * 0.4)(D, P) * (P ** -0.5)
        C_im = (lambda *s: torch.randn(*s, dtype=torch.bfloat16) * 0.4)(D, P) * (P ** -0.5)
        log_dt = (lambda *s: torch.randn(*s, dtype=torch.bfloat16) * 0.4)(P) * 0.3 - 2.0
        Dskip = (lambda *s: torch.randn(*s, dtype=torch.bfloat16) * 0.2)(D)
        return {
            "x": _w((lambda *s: torch.randn(*s, dtype=torch.bfloat16) * 0.05)(B, S, D)),
            "Lambda_re": _w(Lambda_re),
            "Lambda_im": _w(Lambda_im),
            "B_re": _w(B_re),
            "B_im": _w(B_im),
            "C_re": _w(C_re),
            "C_im": _w(C_im),
            "log_dt": _w(log_dt),
            "Dskip": _w(Dskip),
        }
    _A_in = _A_setup()

    def _B_setup():
        B, S, D, F = 1, 2048, 448, 1792
        return {
            "x": _w((lambda *s: torch.randn(*s, dtype=torch.bfloat16) * 0.05)(B, S, D)),
            "w1": _w((lambda *s: torch.randn(*s, dtype=torch.bfloat16) * 0.8)(D, F) * (D ** -0.5)),
            "b1": _w((lambda *s: torch.randn(*s, dtype=torch.bfloat16) * 0.4)(F)),
            "w2": _w((lambda *s: torch.randn(*s, dtype=torch.bfloat16) * 0.1)(F, D) * (F ** -0.5)),
            "b2": _w((lambda *s: torch.randn(*s, dtype=torch.bfloat16) * 0.1)(D)),
        }
    _B_in = _B_setup()

    return {
        "A_x": _A_in["x"],
        "A_Lambda_re": _A_in["Lambda_re"],
        "A_Lambda_im": _A_in["Lambda_im"],
        "A_B_re": _A_in["B_re"],
        "A_B_im": _A_in["B_im"],
        "A_C_re": _A_in["C_re"],
        "A_C_im": _A_in["C_im"],
        "A_log_dt": _A_in["log_dt"],
        "A_Dskip": _A_in["Dskip"],
        "B_x": _B_in["x"],
        "B_w1": _B_in["w1"],
        "B_b1": _B_in["b1"],
        "B_w2": _B_in["w2"],
        "B_b2": _B_in["b2"],
    }

def reference(A_x, A_Lambda_re, A_Lambda_im, A_B_re, A_B_im, A_C_re, A_C_im, A_log_dt, A_Dskip, B_x, B_w1, B_b1, B_w2, B_b2):
    def _A_ref(x, Lambda_re, Lambda_im, B_re, B_im, C_re, C_im, log_dt, Dskip):
        Bsz, L, H = x.shape
        Lam = Lambda_re + 1j * Lambda_im
        Bmat = B_re + 1j * B_im
        Cmat = C_re + 1j * C_im
        dt = torch.exp(log_dt)
        Lam_bar = torch.exp(dt * Lam)
        B_bar = ((Lam_bar - 1.0) / Lam)[:, None] * Bmat
        Bu = torch.einsum("bld,pd->blp", x + 0j, B_bar)
        h = torch.zeros_like(Bu[:, 0, :])
        hs = []
        for t in range(L):
            h = Lam_bar[None, :] * h + Bu[:, t, :]
            hs.append(h)
        hseq = torch.stack(hs, 1)
        y = 2.0 * torch.einsum("blp,dp->bld", hseq, Cmat).real + x * Dskip[None, None, :]
        return y

    def _B_ref(x, w1, b1, w2, b2):
        y = _layernorm(x, axis=-1)
        h = _gelu(torch.einsum("bsd,df->bsf", y, w1) + b1)
        return torch.einsum("bsf,fd->bsd", h, w2) + b2

    x = A_x
    xn = _layernorm(x, axis=-1)
    s = _A_ref(xn, A_Lambda_re, A_Lambda_im, A_B_re, A_B_im, A_C_re, A_C_im, A_log_dt, A_Dskip)
    g = _silu(_B_ref(xn, B_w1, B_b1, B_w2, B_b2))
    return x + s * g
```

```asm
; @launch grid=(256,1,1) block=(256,1,1) lds=160512
.amdgcn_target "amdgcn-amd-amdhsa--gfx950"
.text
.globl recurrent_scan__ssm_conv_s5__mixer_channel_mlp__prompt_kernel
.p2align 8
.type recurrent_scan__ssm_conv_s5__mixer_channel_mlp__prompt_kernel,@function
recurrent_scan__ssm_conv_s5__mixer_channel_mlp__prompt_kernel:
    s_cmp_ge_u32 s2, 256
    s_cbranch_scc1 KP_EXIT
    s_load_dwordx16 s[4:19], s[0:1], 0
    s_load_dwordx16 s[20:35], s[0:1], 64
    s_load_dwordx2 s[36:37], s[0:1], 128
    v_lshrrev_b32 v1, 6, v0
    v_and_b32 v0, 63, v0
    v_readfirstlane_b32 s3, v1
    s_cmp_ge_u32 s2, 224
    s_cbranch_scc1 KP_HELPER
    v_lshrrev_b32 v2, 3, v0
    v_and_b32 v3, 7, v0
    s_lshr_b32 s68, s2, 3
    s_mul_i32 s69, s68, 37
    s_lshr_b32 s69, s69, 8
    s_mul_i32 s41, s69, 7
    s_sub_u32 s41, s68, s41
    s_lshl_b32 s69, s69, 3
    s_and_b32 s40, s2, 7
    s_add_u32 s40, s40, s69
    s_movk_i32 s70, 896
    s_lshl_b32 s68, s40, 6
    s_lshl_b32 s69, s3, 4
    s_add_u32 s68, s68, s69
    v_add_u32 v6, s68, v2
    v_lshlrev_b32 v7, 4, v3
    v_mad_u32_u24 v6, v6, s70, v7
    v_and_b32 v4, 15, v0
    v_lshrrev_b32 v5, 4, v0
    s_lshl_b32 s68, s41, 6
    s_add_u32 s68, s68, s69
    v_add_u32 v8, s68, v4
    v_lshlrev_b32 v8, 1, v8
    s_movk_i32 s80, 7168
    s_waitcnt lgkmcnt(0)
    s_mov_b32 s44, s4
    s_mov_b32 s45, s5
    s_mov_b32 s46, 1835008
    s_mov_b32 s47, 0x00020000
    global_load_ushort v252, v8, s[6:7]
    global_load_ushort v253, v8, s[8:9]
    global_load_ushort v254, v8, s[18:19]
    buffer_load_dwordx4 v[156:159], v6, s[44:47], 0 offen offset:0
    buffer_load_dwordx4 v[160:163], v6, s[44:47], 0 offen offset:128
    buffer_load_dwordx4 v[164:167], v6, s[44:47], 0 offen offset:256
    buffer_load_dwordx4 v[168:171], v6, s[44:47], 0 offen offset:384
    buffer_load_dwordx4 v[172:175], v6, s[44:47], 0 offen offset:512
    buffer_load_dwordx4 v[176:179], v6, s[44:47], 0 offen offset:640
    buffer_load_dwordx4 v[180:183], v6, s[44:47], 0 offen offset:768
    buffer_load_dwordx4 v[184:187], v6, s[44:47], s80 offen offset:0
    buffer_load_dwordx4 v[188:191], v6, s[44:47], s80 offen offset:128
    buffer_load_dwordx4 v[192:195], v6, s[44:47], s80 offen offset:256
    buffer_load_dwordx4 v[196:199], v6, s[44:47], s80 offen offset:384
    buffer_load_dwordx4 v[200:203], v6, s[44:47], s80 offen offset:512
    buffer_load_dwordx4 v[204:207], v6, s[44:47], s80 offen offset:640
    buffer_load_dwordx4 v[208:211], v6, s[44:47], s80 offen offset:768
    s_or_b32 s69, s2, s3
    s_cmp_lg_u32 s69, 0
    s_cbranch_scc1 KP_NONONCE
    s_memrealtime s[38:39]
    s_waitcnt lgkmcnt(0)
    s_or_b32 s38, s38, 1
    v_mov_b32 v10, s38
    v_mov_b32 v11, s39
    v_mov_b32 v9, 0
    s_mov_b64 exec, 1
    global_store_dwordx2 v9, v[10:11], s[34:35] sc1
    s_mov_b64 exec, -1
KP_NONONCE:
    v_add_u32 v9, s68, v2
    v_xor_b32 v7, v3, v2
    v_lshlrev_b32 v7, 4, v7
    v_mad_u32_u24 v16, v9, s70, v7
    v_add_u32 v17, 6144, v16
    s_lshl_b32 s68, s41, 9
    s_lshl_b32 s69, s3, 7
    s_add_u32 s68, s68, s69
    s_movk_i32 s71, 3584
    v_lshrrev_b32 v9, 4, v0
    v_and_b32 v9, 1, v9
    v_lshlrev_b32 v9, 1, v9
    v_xor_b32 v9, v9, v3
    v_xor_b32 v10, 4, v9
    v_lshlrev_b32 v9, 4, v9
    v_lshlrev_b32 v10, 4, v10
    v_mad_u32_u24 v11, v2, s71, 0
    v_add_u32 v11, s68, v11
    v_add_u32 v18, v11, v9
    v_add_u32 v19, v11, v10
    v_add_u32 v20, 55296, v18
    v_add_u32 v21, 82944, v19
    v_add_u32 v19, 27648, v19
    v_lshl_add_u32 v1, v5, 3, s68
    s_mul_i32 s78, s3, 20480
    s_add_u32 s78, s78, 62208
    v_and_b32 v9, 7, v4
    v_xor_b32 v9, v9, v5
    v_xor_b32 v10, 4, v9
    v_lshlrev_b32 v11, 7, v4
    v_add_u32 v11, s78, v11
    v_lshl_add_u32 v22, v9, 4, v11
    v_lshl_add_u32 v23, v10, 4, v11
    v_lshrrev_b32 v9, 2, v4
    v_lshl_add_u32 v9, v5, 3, v9
    v_lshlrev_b32 v9, 7, v9
    v_add_u32 v9, s78, v9
    v_and_b32 v10, 3, v4
    v_lshl_add_u32 v9, v10, 3, v9
    v_lshrrev_b32 v10, 3, v4
    v_lshlrev_b32 v10, 1, v10
    v_and_b32 v11, 1, v5
    v_lshl_or_b32 v10, v11, 2, v10
    v_xor_b32 v11, 0, v10
    v_lshl_add_u32 v24, v11, 4, v9
    v_xor_b32 v11, 2, v10
    v_lshl_add_u32 v25, v11, 4, v9
    v_xor_b32 v11, 4, v10
    v_lshl_add_u32 v26, v11, 4, v9
    v_xor_b32 v11, 6, v10
    v_lshl_add_u32 v27, v11, 4, v9
    v_lshlrev_b32 v12, 4, v0
    s_mov_b32 s48, s10
    s_mov_b32 s49, s11
    s_mov_b32 s50, 401408
    s_mov_b32 s51, 0x00020000
    s_sub_u32 s52, s12, 2048
    s_subb_u32 s53, s13, 0
    s_mov_b32 s54, 403456
    s_mov_b32 s55, 0x00020000
    s_mov_b32 s56, s24
    s_mov_b32 s57, s25
    s_mov_b32 s58, 1605632
    s_mov_b32 s59, 0x00020000
    s_mov_b32 s60, s36
    s_mov_b32 s61, s37
    s_mov_b32 s62, 268435456
    s_mov_b32 s63, 0x00020000
    s_add_u32 s64, s36, 13418496
    s_addc_u32 s65, s37, 0
    s_mov_b32 s66, 229376
    s_mov_b32 s67, 0x00020000
    s_mov_b32 s72, s32
    s_mov_b32 s73, s33
    s_mov_b32 s74, 3670016
    s_mov_b32 s75, 0x00020000
    s_mul_i32 s81, s40, 344064
    s_waitcnt vmcnt(14)
    v_lshlrev_b32 v252, 16, v252
    v_lshlrev_b32 v253, 16, v253
    v_lshlrev_b32 v254, 16, v254
    v_mul_f32 v254, 0x3fb8aa3b, v254
    v_exp_f32 v254, v254
    s_nop 0
    v_cvt_pk_bf16_f32 v254, v254, v254
    v_lshlrev_b32 v254, 16, v254
    v_mul_f32 v10, v254, v252
    v_mul_f32 v11, v254, v253
    v_mul_f32 v10, 0x3fb8aa3b, v10
    v_mul_f32 v11, 0x3e22f983, v11
    v_exp_f32 v10, v10
    v_rndne_f32 v13, v11
    v_sub_f32 v11, v11, v13
    v_cos_f32 v14, v11
    v_sin_f32 v15, v11
    v_mul_f32 v44, v10, v14
    v_mul_f32 v45, v10, v15
    v_add_f32 v10, -1.0, v44
    v_mul_f32 v13, v252, v252
    v_fmac_f32 v13, v253, v253
    v_rcp_f32 v13, v13
    v_mul_f32 v14, v10, v252
    v_fmac_f32 v14, v45, v253
    v_mul_f32 v15, v45, v252
    v_fma_f32 v15, -v10, v253, v15
    v_add_f32 v13, v13, v13
    v_mul_f32 v46, v14, v13
    v_mul_f32 v47, v15, v13
    v_pk_mul_f32 v[14:15], v[44:45], v[44:45] op_sel:[0,0] op_sel_hi:[1,0]
    v_pk_fma_f32 v[10:11], v[44:45], v[44:45], v[14:15] op_sel:[1,1,0] op_sel_hi:[0,1,1] neg_lo:[0,1,0]
    v_pk_mul_f32 v[14:15], v[10:11], v[10:11] op_sel:[0,0] op_sel_hi:[1,0]
    v_pk_fma_f32 v[242:243], v[10:11], v[10:11], v[14:15] op_sel:[1,1,0] op_sel_hi:[0,1,1] neg_lo:[0,1,0]
    v_pk_mul_f32 v[14:15], v[242:243], v[242:243] op_sel:[0,0] op_sel_hi:[1,0]
    v_pk_fma_f32 v[10:11], v[242:243], v[242:243], v[14:15] op_sel:[1,1,0] op_sel_hi:[0,1,1] neg_lo:[0,1,0]
    v_pk_mul_f32 v[14:15], v[10:11], v[10:11] op_sel:[0,0] op_sel_hi:[1,0]
    v_pk_fma_f32 v[48:49], v[10:11], v[10:11], v[14:15] op_sel:[1,1,0] op_sel_hi:[0,1,1] neg_lo:[0,1,0]
    v_pk_mul_f32 v[14:15], v[48:49], v[48:49] op_sel:[0,0] op_sel_hi:[1,0]
    v_pk_fma_f32 v[50:51], v[48:49], v[48:49], v[14:15] op_sel:[1,1,0] op_sel_hi:[0,1,1] neg_lo:[0,1,0]
    v_pk_mul_f32 v[14:15], v[50:51], v[48:49] op_sel:[0,0] op_sel_hi:[1,0]
    v_pk_fma_f32 v[52:53], v[50:51], v[48:49], v[14:15] op_sel:[1,1,0] op_sel_hi:[0,1,1] neg_lo:[0,1,0]
    v_pk_mul_f32 v[14:15], v[50:51], v[50:51] op_sel:[0,0] op_sel_hi:[1,0]
    v_pk_fma_f32 v[54:55], v[50:51], v[50:51], v[14:15] op_sel:[1,1,0] op_sel_hi:[0,1,1] neg_lo:[0,1,0]
    v_pk_mul_f32 v[14:15], v[54:55], v[54:55] op_sel:[0,0] op_sel_hi:[1,0]
    v_pk_fma_f32 v[10:11], v[54:55], v[54:55], v[14:15] op_sel:[1,1,0] op_sel_hi:[0,1,1] neg_lo:[0,1,0]
    v_pk_mul_f32 v[14:15], v[10:11], v[10:11] op_sel:[0,0] op_sel_hi:[1,0]
    v_pk_fma_f32 v[56:57], v[10:11], v[10:11], v[14:15] op_sel:[1,1,0] op_sel_hi:[0,1,1] neg_lo:[0,1,0]
    v_lshrrev_b32 v9, 2, v3
    v_lshlrev_b32 v8, 12, v9
    v_lshrrev_b32 v9, 2, v2
    v_lshl_add_u32 v8, v9, 10, v8
    v_and_b32 v9, 3, v3
    v_lshl_add_u32 v8, v9, 8, v8
    v_and_b32 v9, 3, v2
    s_lshl_b32 s71, s3, 2
    v_add_u32 v9, s71, v9
    v_xor_b32 v9, v9, v3
    v_lshl_add_u32 v8, v9, 4, v8
    s_mov_b32 s68, 0x3f803f80
    s_mov_b32 s69, 0x00003f80
    s_mov_b32 s70, 0x3f800000
    v_mov_b32 v92, 0
    v_mov_b32 v96, 0
    v_mov_b32 v97, 0
    v_mov_b32 v93, 0
    v_mov_b32 v98, 0
    v_mov_b32 v99, 0
    s_waitcnt vmcnt(7)
    v_dot2c_f32_bf16 v92, s68, v156
    v_dot2c_f32_bf16 v92, s68, v157
    v_dot2c_f32_bf16 v92, s68, v158
    v_dot2c_f32_bf16 v92, s68, v159
    v_dot2c_f32_bf16 v92, s68, v160
    v_dot2c_f32_bf16 v92, s68, v161
    v_dot2c_f32_bf16 v92, s68, v162
    v_dot2c_f32_bf16 v92, s68, v163
    v_dot2c_f32_bf16 v92, s68, v164
    v_dot2c_f32_bf16 v92, s68, v165
    v_dot2c_f32_bf16 v92, s68, v166
    v_dot2c_f32_bf16 v92, s68, v167
    v_dot2c_f32_bf16 v92, s68, v168
    v_dot2c_f32_bf16 v92, s68, v169
    v_dot2c_f32_bf16 v92, s68, v170
    v_dot2c_f32_bf16 v92, s68, v171
    v_dot2c_f32_bf16 v92, s68, v172
    v_dot2c_f32_bf16 v92, s68, v173
    v_dot2c_f32_bf16 v92, s68, v174
    v_dot2c_f32_bf16 v92, s68, v175
    s_lshr_b32 s76, s40, 3
    s_mul_i32 s76, s76, 2
    s_add_u32 m0, s78, 0
    s_lshl_b32 s79, s76, 7
    buffer_load_dwordx4 v16, s[48:51], s79 offen lds
    v_dot2c_f32_bf16 v92, s68, v176
    v_dot2c_f32_bf16 v92, s68, v177
    v_dot2c_f32_bf16 v92, s68, v178
    v_dot2c_f32_bf16 v92, s68, v179
    v_dot2c_f32_bf16 v92, s68, v180
    v_dot2c_f32_bf16 v92, s68, v181
    v_dot2c_f32_bf16 v92, s68, v182
    v_dot2c_f32_bf16 v92, s68, v183
    s_nop 2
    v_add_f32_dpp v92, v92, v92 quad_perm:[1,0,3,2] row_mask:0xf bank_mask:0xf
    s_nop 1
    v_add_f32_dpp v92, v92, v92 quad_perm:[2,3,0,1] row_mask:0xf bank_mask:0xf
    s_nop 1
    s_nop 0
    v_add_f32_dpp v92, v92, v92 row_half_mirror row_mask:0xf bank_mask:0xf
    v_mul_f32 v94, 0xbb124925, v92
    v_dot2_f32_bf16 v100, v156, s69, v94
    v_dot2_f32_bf16 v101, v156, s70, v94
    v_dot2_f32_bf16 v102, v157, s69, v94
    v_dot2_f32_bf16 v103, v157, s70, v94
    v_dot2_f32_bf16 v104, v158, s69, v94
    buffer_load_dwordx4 v17, s[48:51], s79 offen offset:1024 lds
    v_dot2_f32_bf16 v105, v158, s70, v94
    v_dot2_f32_bf16 v106, v159, s69, v94
    v_dot2_f32_bf16 v107, v159, s70, v94
    v_pk_fma_f32 v[96:97], v[100:101], v[100:101], v[96:97]
    v_cvt_pk_bf16_f32 v156, v100, v101
    v_pk_fma_f32 v[96:97], v[102:103], v[102:103], v[96:97]
    v_cvt_pk_bf16_f32 v157, v102, v103
    v_pk_fma_f32 v[96:97], v[104:105], v[104:105], v[96:97]
    v_cvt_pk_bf16_f32 v158, v104, v105
    v_pk_fma_f32 v[96:97], v[106:107], v[106:107], v[96:97]
    v_cvt_pk_bf16_f32 v159, v106, v107
    ds_write_b128 v8, v[156:159] offset:4864
    v_dot2_f32_bf16 v108, v160, s69, v94
    v_dot2_f32_bf16 v109, v160, s70, v94
    v_dot2_f32_bf16 v110, v161, s69, v94
    v_dot2_f32_bf16 v111, v161, s70, v94
    v_dot2_f32_bf16 v112, v162, s69, v94
    buffer_load_dwordx4 v16, s[52:55], s79 offen offset:2048 lds
    v_dot2_f32_bf16 v113, v162, s70, v94
    v_dot2_f32_bf16 v114, v163, s69, v94
    v_dot2_f32_bf16 v115, v163, s70, v94
    v_pk_fma_f32 v[96:97], v[108:109], v[108:109], v[96:97]
    v_cvt_pk_bf16_f32 v160, v108, v109
    v_pk_fma_f32 v[96:97], v[110:111], v[110:111], v[96:97]
    v_cvt_pk_bf16_f32 v161, v110, v111
    v_pk_fma_f32 v[96:97], v[112:113], v[112:113], v[96:97]
    v_cvt_pk_bf16_f32 v162, v112, v113
    v_pk_fma_f32 v[96:97], v[114:115], v[114:115], v[96:97]
    v_cvt_pk_bf16_f32 v163, v114, v115
    ds_write_b128 v8, v[160:163] offset:13056
    v_dot2_f32_bf16 v100, v164, s69, v94
    v_dot2_f32_bf16 v101, v164, s70, v94
    v_dot2_f32_bf16 v102, v165, s69, v94
    v_dot2_f32_bf16 v103, v165, s70, v94
    v_dot2_f32_bf16 v104, v166, s69, v94
    buffer_load_dwordx4 v17, s[52:55], s79 offen offset:3072 lds
    s_add_u32 s76, s76, 1
    s_cmp_eq_u32 s76, 7
    s_cselect_b32 s76, 0, s76
    s_nop 0
    v_dot2_f32_bf16 v105, v166, s70, v94
    v_dot2_f32_bf16 v106, v167, s69, v94
    v_dot2_f32_bf16 v107, v167, s70, v94
    v_pk_fma_f32 v[96:97], v[100:101], v[100:101], v[96:97]
    v_cvt_pk_bf16_f32 v164, v100, v101
    v_pk_fma_f32 v[96:97], v[102:103], v[102:103], v[96:97]
    v_cvt_pk_bf16_f32 v165, v102, v103
    v_pk_fma_f32 v[96:97], v[104:105], v[104:105], v[96:97]
    v_cvt_pk_bf16_f32 v166, v104, v105
    v_pk_fma_f32 v[96:97], v[106:107], v[106:107], v[96:97]
    v_cvt_pk_bf16_f32 v167, v106, v107
    ds_write_b128 v8, v[164:167] offset:21248
    v_dot2_f32_bf16 v108, v168, s69, v94
    v_dot2_f32_bf16 v109, v168, s70, v94
    v_dot2_f32_bf16 v110, v169, s69, v94
    v_dot2_f32_bf16 v111, v169, s70, v94
    v_dot2_f32_bf16 v112, v170, s69, v94
    s_add_u32 m0, s78, 4096
    s_lshl_b32 s79, s76, 7
    s_nop 0
    buffer_load_dwordx4 v16, s[48:51], s79 offen lds
    v_dot2_f32_bf16 v113, v170, s70, v94
    v_dot2_f32_bf16 v114, v171, s69, v94
    v_dot2_f32_bf16 v115, v171, s70, v94
    v_pk_fma_f32 v[96:97], v[108:109], v[108:109], v[96:97]
    v_cvt_pk_bf16_f32 v168, v108, v109
    v_pk_fma_f32 v[96:97], v[110:111], v[110:111], v[96:97]
    v_cvt_pk_bf16_f32 v169, v110, v111
    v_pk_fma_f32 v[96:97], v[112:113], v[112:113], v[96:97]
    v_cvt_pk_bf16_f32 v170, v112, v113
    v_pk_fma_f32 v[96:97], v[114:115], v[114:115], v[96:97]
    v_cvt_pk_bf16_f32 v171, v114, v115
    ds_write_b128 v8, v[168:171] offset:29440
    v_dot2_f32_bf16 v100, v172, s69, v94
    v_dot2_f32_bf16 v101, v172, s70, v94
    v_dot2_f32_bf16 v102, v173, s69, v94
    v_dot2_f32_bf16 v103, v173, s70, v94
    v_dot2_f32_bf16 v104, v174, s69, v94
    buffer_load_dwordx4 v17, s[48:51], s79 offen offset:1024 lds
    v_dot2_f32_bf16 v105, v174, s70, v94
    v_dot2_f32_bf16 v106, v175, s69, v94
    v_dot2_f32_bf16 v107, v175, s70, v94
    v_pk_fma_f32 v[96:97], v[100:101], v[100:101], v[96:97]
    v_cvt_pk_bf16_f32 v172, v100, v101
    v_pk_fma_f32 v[96:97], v[102:103], v[102:103], v[96:97]
    v_cvt_pk_bf16_f32 v173, v102, v103
    v_pk_fma_f32 v[96:97], v[104:105], v[104:105], v[96:97]
    v_cvt_pk_bf16_f32 v174, v104, v105
    v_pk_fma_f32 v[96:97], v[106:107], v[106:107], v[96:97]
    v_cvt_pk_bf16_f32 v175, v106, v107
    ds_write_b128 v8, v[172:175] offset:37632
    v_dot2_f32_bf16 v108, v176, s69, v94
    v_dot2_f32_bf16 v109, v176, s70, v94
    v_dot2_f32_bf16 v110, v177, s69, v94
    v_dot2_f32_bf16 v111, v177, s70, v94
    v_dot2_f32_bf16 v112, v178, s69, v94
    buffer_load_dwordx4 v16, s[52:55], s79 offen offset:2048 lds
    v_dot2_f32_bf16 v113, v178, s70, v94
    v_dot2_f32_bf16 v114, v179, s69, v94
    v_dot2_f32_bf16 v115, v179, s70, v94
    v_pk_fma_f32 v[96:97], v[108:109], v[108:109], v[96:97]
    v_cvt_pk_bf16_f32 v176, v108, v109
    v_pk_fma_f32 v[96:97], v[110:111], v[110:111], v[96:97]
    v_cvt_pk_bf16_f32 v177, v110, v111
    v_pk_fma_f32 v[96:97], v[112:113], v[112:113], v[96:97]
    v_cvt_pk_bf16_f32 v178, v112, v113
    v_pk_fma_f32 v[96:97], v[114:115], v[114:115], v[96:97]
    v_cvt_pk_bf16_f32 v179, v114, v115
    ds_write_b128 v8, v[176:179] offset:45824
    v_dot2_f32_bf16 v100, v180, s69, v94
    v_dot2_f32_bf16 v101, v180, s70, v94
    v_dot2_f32_bf16 v102, v181, s69, v94
    v_dot2_f32_bf16 v103, v181, s70, v94
    v_dot2_f32_bf16 v104, v182, s69, v94
    buffer_load_dwordx4 v17, s[52:55], s79 offen offset:3072 lds
    s_add_u32 s76, s76, 1
    s_cmp_eq_u32 s76, 7
    s_cselect_b32 s76, 0, s76
    s_nop 0
    v_dot2_f32_bf16 v105, v182, s70, v94
    v_dot2_f32_bf16 v106, v183, s69, v94
    v_dot2_f32_bf16 v107, v183, s70, v94
    v_pk_fma_f32 v[96:97], v[100:101], v[100:101], v[96:97]
    v_cvt_pk_bf16_f32 v180, v100, v101
    v_pk_fma_f32 v[96:97], v[102:103], v[102:103], v[96:97]
    v_cvt_pk_bf16_f32 v181, v102, v103
    v_pk_fma_f32 v[96:97], v[104:105], v[104:105], v[96:97]
    v_cvt_pk_bf16_f32 v182, v104, v105
    v_pk_fma_f32 v[96:97], v[106:107], v[106:107], v[96:97]
    v_cvt_pk_bf16_f32 v183, v106, v107
    ds_write_b128 v8, v[180:183] offset:54016
    s_waitcnt vmcnt(8)
    v_dot2c_f32_bf16 v93, s68, v184
    v_dot2c_f32_bf16 v93, s68, v185
    v_dot2c_f32_bf16 v93, s68, v186
    s_add_u32 m0, s78, 8192
    s_lshl_b32 s79, s76, 7
    buffer_load_dwordx4 v16, s[48:51], s79 offen lds
    v_dot2c_f32_bf16 v93, s68, v187
    v_dot2c_f32_bf16 v93, s68, v188
    v_dot2c_f32_bf16 v93, s68, v189
    v_dot2c_f32_bf16 v93, s68, v190
    v_dot2c_f32_bf16 v93, s68, v191
    v_dot2c_f32_bf16 v93, s68, v192
    v_dot2c_f32_bf16 v93, s68, v193
    v_dot2c_f32_bf16 v93, s68, v194
    v_dot2c_f32_bf16 v93, s68, v195
    v_dot2c_f32_bf16 v93, s68, v196
    v_dot2c_f32_bf16 v93, s68, v197
    v_dot2c_f32_bf16 v93, s68, v198
    v_dot2c_f32_bf16 v93, s68, v199
    v_dot2c_f32_bf16 v93, s68, v200
    v_dot2c_f32_bf16 v93, s68, v201
    v_dot2c_f32_bf16 v93, s68, v202
    v_dot2c_f32_bf16 v93, s68, v203
    buffer_load_dwordx4 v17, s[48:51], s79 offen offset:1024 lds
    v_dot2c_f32_bf16 v93, s68, v204
    v_dot2c_f32_bf16 v93, s68, v205
    v_dot2c_f32_bf16 v93, s68, v206
    v_dot2c_f32_bf16 v93, s68, v207
    v_dot2c_f32_bf16 v93, s68, v208
    v_dot2c_f32_bf16 v93, s68, v209
    v_dot2c_f32_bf16 v93, s68, v210
    v_dot2c_f32_bf16 v93, s68, v211
    s_nop 2
    v_add_f32_dpp v93, v93, v93 quad_perm:[1,0,3,2] row_mask:0xf bank_mask:0xf
    s_nop 1
    v_add_f32_dpp v93, v93, v93 quad_perm:[2,3,0,1] row_mask:0xf bank_mask:0xf
    s_nop 1
    s_nop 0
    v_add_f32_dpp v93, v93, v93 row_half_mirror row_mask:0xf bank_mask:0xf
    v_mul_f32 v95, 0xbb124925, v93
    v_dot2_f32_bf16 v100, v184, s69, v95
    v_dot2_f32_bf16 v101, v184, s70, v95
    v_dot2_f32_bf16 v102, v185, s69, v95
    v_dot2_f32_bf16 v103, v185, s70, v95
    v_dot2_f32_bf16 v104, v186, s69, v95
    buffer_load_dwordx4 v16, s[52:55], s79 offen offset:2048 lds
    v_dot2_f32_bf16 v105, v186, s70, v95
    v_dot2_f32_bf16 v106, v187, s69, v95
    v_dot2_f32_bf16 v107, v187, s70, v95
    v_pk_fma_f32 v[98:99], v[100:101], v[100:101], v[98:99]
    v_cvt_pk_bf16_f32 v184, v100, v101
    v_pk_fma_f32 v[98:99], v[102:103], v[102:103], v[98:99]
    v_cvt_pk_bf16_f32 v185, v102, v103
    v_pk_fma_f32 v[98:99], v[104:105], v[104:105], v[98:99]
    v_cvt_pk_bf16_f32 v186, v104, v105
    v_pk_fma_f32 v[98:99], v[106:107], v[106:107], v[98:99]
    v_cvt_pk_bf16_f32 v187, v106, v107
    ds_write_b128 v8, v[184:187] offset:6912
    v_dot2_f32_bf16 v108, v188, s69, v95
    v_dot2_f32_bf16 v109, v188, s70, v95
    v_dot2_f32_bf16 v110, v189, s69, v95
    v_dot2_f32_bf16 v111, v189, s70, v95
    v_dot2_f32_bf16 v112, v190, s69, v95
    buffer_load_dwordx4 v17, s[52:55], s79 offen offset:3072 lds
    s_add_u32 s76, s76, 1
    s_cmp_eq_u32 s76, 7
    s_cselect_b32 s76, 0, s76
    s_nop 0
    v_dot2_f32_bf16 v113, v190, s70, v95
    v_dot2_f32_bf16 v114, v191, s69, v95
    v_dot2_f32_bf16 v115, v191, s70, v95
    v_pk_fma_f32 v[98:99], v[108:109], v[108:109], v[98:99]
    v_cvt_pk_bf16_f32 v188, v108, v109
    v_pk_fma_f32 v[98:99], v[110:111], v[110:111], v[98:99]
    v_cvt_pk_bf16_f32 v189, v110, v111
    v_pk_fma_f32 v[98:99], v[112:113], v[112:113], v[98:99]
    v_cvt_pk_bf16_f32 v190, v112, v113
    v_pk_fma_f32 v[98:99], v[114:115], v[114:115], v[98:99]
    v_cvt_pk_bf16_f32 v191, v114, v115
    ds_write_b128 v8, v[188:191] offset:15104
    v_dot2_f32_bf16 v100, v192, s69, v95
    v_dot2_f32_bf16 v101, v192, s70, v95
    v_dot2_f32_bf16 v102, v193, s69, v95
    v_dot2_f32_bf16 v103, v193, s70, v95
    v_dot2_f32_bf16 v104, v194, s69, v95
    s_add_u32 m0, s78, 12288
    s_lshl_b32 s79, s76, 7
    s_nop 0
    buffer_load_dwordx4 v16, s[48:51], s79 offen lds
    v_dot2_f32_bf16 v105, v194, s70, v95
    v_dot2_f32_bf16 v106, v195, s69, v95
    v_dot2_f32_bf16 v107, v195, s70, v95
    v_pk_fma_f32 v[98:99], v[100:101], v[100:101], v[98:99]
    v_cvt_pk_bf16_f32 v192, v100, v101
    v_pk_fma_f32 v[98:99], v[102:103], v[102:103], v[98:99]
    v_cvt_pk_bf16_f32 v193, v102, v103
    v_pk_fma_f32 v[98:99], v[104:105], v[104:105], v[98:99]
    v_cvt_pk_bf16_f32 v194, v104, v105
    v_pk_fma_f32 v[98:99], v[106:107], v[106:107], v[98:99]
    v_cvt_pk_bf16_f32 v195, v106, v107
    ds_write_b128 v8, v[192:195] offset:23296
    v_dot2_f32_bf16 v108, v196, s69, v95
    v_dot2_f32_bf16 v109, v196, s70, v95
    v_dot2_f32_bf16 v110, v197, s69, v95
    v_dot2_f32_bf16 v111, v197, s70, v95
    v_dot2_f32_bf16 v112, v198, s69, v95
    buffer_load_dwordx4 v17, s[48:51], s79 offen offset:1024 lds
    v_dot2_f32_bf16 v113, v198, s70, v95
    v_dot2_f32_bf16 v114, v199, s69, v95
    v_dot2_f32_bf16 v115, v199, s70, v95
    v_pk_fma_f32 v[98:99], v[108:109], v[108:109], v[98:99]
    v_cvt_pk_bf16_f32 v196, v108, v109
    v_pk_fma_f32 v[98:99], v[110:111], v[110:111], v[98:99]
    v_cvt_pk_bf16_f32 v197, v110, v111
    v_pk_fma_f32 v[98:99], v[112:113], v[112:113], v[98:99]
    v_cvt_pk_bf16_f32 v198, v112, v113
    v_pk_fma_f32 v[98:99], v[114:115], v[114:115], v[98:99]
    v_cvt_pk_bf16_f32 v199, v114, v115
    ds_write_b128 v8, v[196:199] offset:31488
    v_dot2_f32_bf16 v100, v200, s69, v95
    v_dot2_f32_bf16 v101, v200, s70, v95
    v_dot2_f32_bf16 v102, v201, s69, v95
    v_dot2_f32_bf16 v103, v201, s70, v95
    v_dot2_f32_bf16 v104, v202, s69, v95
    buffer_load_dwordx4 v16, s[52:55], s79 offen offset:2048 lds
    v_dot2_f32_bf16 v105, v202, s70, v95
    v_dot2_f32_bf16 v106, v203, s69, v95
    v_dot2_f32_bf16 v107, v203, s70, v95
    v_pk_fma_f32 v[98:99], v[100:101], v[100:101], v[98:99]
    v_cvt_pk_bf16_f32 v200, v100, v101
    v_pk_fma_f32 v[98:99], v[102:103], v[102:103], v[98:99]
    v_cvt_pk_bf16_f32 v201, v102, v103
    v_pk_fma_f32 v[98:99], v[104:105], v[104:105], v[98:99]
    v_cvt_pk_bf16_f32 v202, v104, v105
    v_pk_fma_f32 v[98:99], v[106:107], v[106:107], v[98:99]
    v_cvt_pk_bf16_f32 v203, v106, v107
    ds_write_b128 v8, v[200:203] offset:39680
    v_dot2_f32_bf16 v108, v204, s69, v95
    v_dot2_f32_bf16 v109, v204, s70, v95
    v_dot2_f32_bf16 v110, v205, s69, v95
    v_dot2_f32_bf16 v111, v205, s70, v95
    v_dot2_f32_bf16 v112, v206, s69, v95
    buffer_load_dwordx4 v17, s[52:55], s79 offen offset:3072 lds
    s_add_u32 s76, s76, 1
    s_cmp_eq_u32 s76, 7
    s_cselect_b32 s76, 0, s76
    s_nop 0
    v_dot2_f32_bf16 v113, v206, s70, v95
    v_dot2_f32_bf16 v114, v207, s69, v95
    v_dot2_f32_bf16 v115, v207, s70, v95
    v_pk_fma_f32 v[98:99], v[108:109], v[108:109], v[98:99]
    v_cvt_pk_bf16_f32 v204, v108, v109
    v_pk_fma_f32 v[98:99], v[110:111], v[110:111], v[98:99]
    v_cvt_pk_bf16_f32 v205, v110, v111
    v_pk_fma_f32 v[98:99], v[112:113], v[112:113], v[98:99]
    v_cvt_pk_bf16_f32 v206, v112, v113
    v_pk_fma_f32 v[98:99], v[114:115], v[114:115], v[98:99]
    v_cvt_pk_bf16_f32 v207, v114, v115
    ds_write_b128 v8, v[204:207] offset:47872
    v_dot2_f32_bf16 v100, v208, s69, v95
    v_dot2_f32_bf16 v101, v208, s70, v95
    v_dot2_f32_bf16 v102, v209, s69, v95
    v_dot2_f32_bf16 v103, v209, s70, v95
    v_dot2_f32_bf16 v104, v210, s69, v95
    v_dot2_f32_bf16 v105, v210, s70, v95
    v_dot2_f32_bf16 v106, v211, s69, v95
    v_dot2_f32_bf16 v107, v211, s70, v95
    v_pk_fma_f32 v[98:99], v[100:101], v[100:101], v[98:99]
    v_cvt_pk_bf16_f32 v208, v100, v101
    v_pk_fma_f32 v[98:99], v[102:103], v[102:103], v[98:99]
    v_cvt_pk_bf16_f32 v209, v102, v103
    v_pk_fma_f32 v[98:99], v[104:105], v[104:105], v[98:99]
    v_cvt_pk_bf16_f32 v210, v104, v105
    v_pk_fma_f32 v[98:99], v[106:107], v[106:107], v[98:99]
    v_cvt_pk_bf16_f32 v211, v106, v107
    ds_write_b128 v8, v[208:211] offset:56064
    v_add_f32 v96, v96, v97
    v_add_f32 v98, v98, v99
    s_nop 0
    v_add_f32_dpp v96, v96, v96 quad_perm:[1,0,3,2] row_mask:0xf bank_mask:0xf
    v_add_f32_dpp v98, v98, v98 quad_perm:[1,0,3,2] row_mask:0xf bank_mask:0xf
    s_nop 0
    v_add_f32_dpp v96, v96, v96 quad_perm:[2,3,0,1] row_mask:0xf bank_mask:0xf
    v_add_f32_dpp v98, v98, v98 quad_perm:[2,3,0,1] row_mask:0xf bank_mask:0xf
    s_nop 0
    s_nop 0
    v_add_f32_dpp v96, v96, v96 row_half_mirror row_mask:0xf bank_mask:0xf
    v_add_f32_dpp v98, v98, v98 row_half_mirror row_mask:0xf bank_mask:0xf
    v_mul_f32 v100, 0x3b124925, v96
    v_mul_f32 v101, 0x3b124925, v98
    v_mov_b32 v102, v100
    v_mov_b32 v103, v101
    v_cvt_pk_bf16_f32 v102, v102, v102
    v_lshlrev_b32 v102, 16, v102
    v_cvt_pk_bf16_f32 v103, v103, v103
    v_lshlrev_b32 v103, 16, v103
    v_add_f32 v102, 0x3727c5ac, v102
    v_add_f32 v103, 0x3727c5ac, v103
    v_cvt_pk_bf16_f32 v102, v102, v102
    v_lshlrev_b32 v102, 16, v102
    v_cvt_pk_bf16_f32 v103, v103, v103
    v_lshlrev_b32 v103, 16, v103
    v_sqrt_f32 v102, v102
    v_sqrt_f32 v103, v103
    v_sub_f32 v108, 0, v94
    v_sub_f32 v109, 0, v95
    v_cvt_pk_bf16_f32 v102, v102, v102
    v_lshlrev_b32 v102, 16, v102
    v_cvt_pk_bf16_f32 v103, v103, v103
    v_lshlrev_b32 v103, 16, v103
    v_rcp_f32 v104, v102
    v_rcp_f32 v105, v103
    v_cvt_pk_bf16_f32 v108, v108, v108
    v_lshlrev_b32 v108, 16, v108
    v_cvt_pk_bf16_f32 v109, v109, v109
    v_lshlrev_b32 v109, 16, v109
    v_mul_f32 v100, v100, v104
    v_mul_f32 v101, v101, v105
    v_mul_f32 v100, v100, v104
    v_mul_f32 v101, v101, v105
    v_cvt_pk_bf16_f32 v100, v100, v100
    v_lshlrev_b32 v100, 16, v100
    v_cvt_pk_bf16_f32 v101, v101, v101
    v_lshlrev_b32 v101, 16, v101
    v_add_f32 v100, 0x3727c5ac, v100
    v_add_f32 v101, 0x3727c5ac, v101
    v_cvt_pk_bf16_f32 v100, v100, v100
    v_lshlrev_b32 v100, 16, v100
    v_cvt_pk_bf16_f32 v101, v101, v101
    v_lshlrev_b32 v101, 16, v101
    v_sqrt_f32 v100, v100
    v_sqrt_f32 v101, v101
    s_lshl_b32 s71, s3, 4
    v_add_u32 v9, s71, v2
    v_cvt_pk_bf16_f32 v100, v100, v100
    v_lshlrev_b32 v100, 16, v100
    v_cvt_pk_bf16_f32 v101, v101, v101
    v_lshlrev_b32 v101, 16, v101
    v_lshlrev_b32 v10, 2, v9
    v_rcp_f32 v100, v100
    v_rcp_f32 v101, v101
    ds_write_b32 v10, v104 offset:0
    ds_write_b32 v10, v108 offset:512
    ds_write_b32 v10, v105 offset:32
    ds_write_b32 v10, v109 offset:544
    v_mul_f32 v106, v104, v100
    v_mul_f32 v107, v105, v101
    ds_write_b32 v10, v106 offset:256
    ds_write_b32 v10, v107 offset:288
    v_xor_b32 v9, v4, v5
    v_xor_b32 v10, 4, v9
    v_lshlrev_b32 v11, 8, v5
    v_lshl_add_u32 v6, v9, 4, v11
    v_lshl_add_u32 v7, v10, 4, v11
    v_lshlrev_b32 v11, 6, v5
    v_lshrrev_b32 v9, 2, v4
    v_lshlrev_b32 v9, 4, v9
    v_and_b32 v10, 3, v4
    v_add_lshl_u32 v9, v9, v10, 2
    s_waitcnt lgkmcnt(0)
    s_barrier
    s_lshr_b32 s77, s40, 3
    s_mul_i32 s77, s77, 2
    s_lshl_b32 s71, s77, 13
    v_add_u32 v1, s71, v6
    v_add_u32 v8, s71, v7
    s_add_u32 s77, s77, 1
    s_cmp_eq_u32 s77, 7
    s_cselect_b32 s77, 0, s77
    s_waitcnt vmcnt(12)
    ds_read_b128 a[0:3], v1 offset:4864
    ds_read_b128 a[4:7], v1 offset:5888
    ds_read_b128 a[8:11], v1 offset:6912
    ds_read_b128 a[12:15], v1 offset:7936
    ds_read_b128 v[92:95], v22 offset:0
    ds_read_b128 v[96:99], v22 offset:2048
    ds_read_b128 a[16:19], v8 offset:8960
    ds_read_b128 a[20:23], v8 offset:9984
    ds_read_b128 a[24:27], v8 offset:11008
    ds_read_b128 a[28:31], v8 offset:12032
    ds_read_b128 v[100:103], v23 offset:0
    ds_read_b128 v[104:107], v23 offset:2048
    ds_read_b32 v220, v9 offset:256
    ds_read_b32 v221, v9 offset:272
    ds_read_b32 v222, v9 offset:288
    ds_read_b32 v223, v9 offset:304
    ds_read_b128 v[226:229], v11 offset:0
    ds_read_b128 v[230:233], v11 offset:16
    ds_read_b128 v[234:237], v11 offset:32
    ds_read_b128 v[238:241], v11 offset:48
    s_waitcnt lgkmcnt(8)
    v_mfma_f32_16x16x32_bf16 v[124:127], a[0:3], v[92:95], 0
    s_add_u32 m0, s78, 16384
    s_lshl_b32 s79, s76, 7
    v_mfma_f32_16x16x32_bf16 v[128:131], a[0:3], v[96:99], 0
    buffer_load_dwordx4 v16, s[48:51], s79 offen lds
    s_lshl_b32 s71, s77, 13
    v_mfma_f32_16x16x32_bf16 v[132:135], a[4:7], v[92:95], 0
    v_add_u32 v1, s71, v6
    v_add_u32 v8, s71, v7
    v_mfma_f32_16x16x32_bf16 v[136:139], a[4:7], v[96:99], 0
    s_add_u32 s77, s77, 1
    s_cmp_eq_u32 s77, 7
    v_mfma_f32_16x16x32_bf16 v[140:143], a[8:11], v[92:95], 0
    s_cselect_b32 s77, 0, s77
    s_waitcnt vmcnt(9)
    v_mfma_f32_16x16x32_bf16 v[144:147], a[8:11], v[96:99], 0
    buffer_load_dwordx4 v17, s[48:51], s79 offen offset:1024 lds
    ds_read_b128 a[32:35], v1 offset:4864
    v_mfma_f32_16x16x32_bf16 v[148:151], a[12:15], v[92:95], 0
    ds_read_b128 a[36:39], v1 offset:5888
    ds_read_b128 a[40:43], v1 offset:6912
    v_mfma_f32_16x16x32_bf16 v[152:155], a[12:15], v[96:99], 0
    ds_read_b128 a[44:47], v1 offset:7936
    ds_read_b128 v[108:111], v22 offset:4096
    v_mfma_f32_16x16x32_bf16 v[124:127], a[16:19], v[100:103], v[124:127]
    ds_read_b128 v[112:115], v22 offset:6144
    ds_read_b128 a[48:51], v8 offset:8960
    v_mfma_f32_16x16x32_bf16 v[128:131], a[16:19], v[104:107], v[128:131]
    buffer_load_dwordx4 v16, s[52:55], s79 offen offset:2048 lds
    ds_read_b128 a[52:55], v8 offset:9984
    v_mfma_f32_16x16x32_bf16 v[132:135], a[20:23], v[100:103], v[132:135]
    ds_read_b128 a[56:59], v8 offset:11008
    ds_read_b128 a[60:63], v8 offset:12032
    v_mfma_f32_16x16x32_bf16 v[136:139], a[20:23], v[104:107], v[136:139]
    ds_read_b128 v[116:119], v23 offset:4096
    ds_read_b128 v[120:123], v23 offset:6144
    v_mfma_f32_16x16x32_bf16 v[140:143], a[24:27], v[100:103], v[140:143]
    v_mfma_f32_16x16x32_bf16 v[144:147], a[24:27], v[104:107], v[144:147]
    buffer_load_dwordx4 v17, s[52:55], s79 offen offset:3072 lds
    s_add_u32 s76, s76, 1
    s_cmp_eq_u32 s76, 7
    s_cselect_b32 s76, 0, s76
    v_mfma_f32_16x16x32_bf16 v[148:151], a[28:31], v[100:103], v[148:151]
    v_mfma_f32_16x16x32_bf16 v[152:155], a[28:31], v[104:107], v[152:155]
    s_waitcnt lgkmcnt(0)
    v_mfma_f32_16x16x32_bf16 v[124:127], a[32:35], v[108:111], v[124:127]
    s_add_u32 m0, s78, 0
    s_lshl_b32 s79, s76, 7
    v_mfma_f32_16x16x32_bf16 v[128:131], a[32:35], v[112:115], v[128:131]
    buffer_load_dwordx4 v16, s[48:51], s79 offen lds
    s_lshl_b32 s71, s77, 13
    v_mfma_f32_16x16x32_bf16 v[132:135], a[36:39], v[108:111], v[132:135]
    v_add_u32 v1, s71, v6
    v_add_u32 v8, s71, v7
    v_mfma_f32_16x16x32_bf16 v[136:139], a[36:39], v[112:115], v[136:139]
    s_add_u32 s77, s77, 1
    s_cmp_eq_u32 s77, 7
    v_mfma_f32_16x16x32_bf16 v[140:143], a[40:43], v[108:111], v[140:143]
    s_cselect_b32 s77, 0, s77
    s_waitcnt vmcnt(9)
    v_mfma_f32_16x16x32_bf16 v[144:147], a[40:43], v[112:115], v[144:147]
    buffer_load_dwordx4 v17, s[48:51], s79 offen offset:1024 lds
    ds_read_b128 a[64:67], v1 offset:4864
    v_mfma_f32_16x16x32_bf16 v[148:151], a[44:47], v[108:111], v[148:151]
    ds_read_b128 a[68:71], v1 offset:5888
    ds_read_b128 a[72:75], v1 offset:6912
    v_mfma_f32_16x16x32_bf16 v[152:155], a[44:47], v[112:115], v[152:155]
    ds_read_b128 a[76:79], v1 offset:7936
    ds_read_b128 v[92:95], v22 offset:8192
    v_mfma_f32_16x16x32_bf16 v[124:127], a[48:51], v[116:119], v[124:127]
    ds_read_b128 v[96:99], v22 offset:10240
    ds_read_b128 a[80:83], v8 offset:8960
    v_mfma_f32_16x16x32_bf16 v[128:131], a[48:51], v[120:123], v[128:131]
    buffer_load_dwordx4 v16, s[52:55], s79 offen offset:2048 lds
    ds_read_b128 a[84:87], v8 offset:9984
    v_mfma_f32_16x16x32_bf16 v[132:135], a[52:55], v[116:119], v[132:135]
    ds_read_b128 a[88:91], v8 offset:11008
    ds_read_b128 a[92:95], v8 offset:12032
    v_mfma_f32_16x16x32_bf16 v[136:139], a[52:55], v[120:123], v[136:139]
    ds_read_b128 v[100:103], v23 offset:8192
    ds_read_b128 v[104:107], v23 offset:10240
    v_mfma_f32_16x16x32_bf16 v[140:143], a[56:59], v[116:119], v[140:143]
    v_mfma_f32_16x16x32_bf16 v[144:147], a[56:59], v[120:123], v[144:147]
    buffer_load_dwordx4 v17, s[52:55], s79 offen offset:3072 lds
    s_add_u32 s76, s76, 1
    s_cmp_eq_u32 s76, 7
    s_cselect_b32 s76, 0, s76
    v_mfma_f32_16x16x32_bf16 v[148:151], a[60:63], v[116:119], v[148:151]
    v_mfma_f32_16x16x32_bf16 v[152:155], a[60:63], v[120:123], v[152:155]
    s_waitcnt lgkmcnt(0)
    v_mfma_f32_16x16x32_bf16 v[124:127], a[64:67], v[92:95], v[124:127]
    s_add_u32 m0, s78, 4096
    s_lshl_b32 s79, s76, 7
    v_mfma_f32_16x16x32_bf16 v[128:131], a[64:67], v[96:99], v[128:131]
    buffer_load_dwordx4 v16, s[48:51], s79 offen lds
    s_lshl_b32 s71, s77, 13
    v_mfma_f32_16x16x32_bf16 v[132:135], a[68:71], v[92:95], v[132:135]
    v_add_u32 v1, s71, v6
    v_add_u32 v8, s71, v7
    v_mfma_f32_16x16x32_bf16 v[136:139], a[68:71], v[96:99], v[136:139]
    s_add_u32 s77, s77, 1
    s_cmp_eq_u32 s77, 7
    v_mfma_f32_16x16x32_bf16 v[140:143], a[72:75], v[92:95], v[140:143]
    s_cselect_b32 s77, 0, s77
    s_waitcnt vmcnt(9)
    v_mfma_f32_16x16x32_bf16 v[144:147], a[72:75], v[96:99], v[144:147]
    buffer_load_dwordx4 v17, s[48:51], s79 offen offset:1024 lds
    ds_read_b128 a[96:99], v1 offset:4864
    v_mfma_f32_16x16x32_bf16 v[148:151], a[76:79], v[92:95], v[148:151]
    ds_read_b128 a[100:103], v1 offset:5888
    ds_read_b128 a[104:107], v1 offset:6912
    v_mfma_f32_16x16x32_bf16 v[152:155], a[76:79], v[96:99], v[152:155]
    ds_read_b128 a[108:111], v1 offset:7936
    ds_read_b128 v[108:111], v22 offset:12288
    v_mfma_f32_16x16x32_bf16 v[124:127], a[80:83], v[100:103], v[124:127]
    ds_read_b128 v[112:115], v22 offset:14336
    ds_read_b128 a[112:115], v8 offset:8960
    v_mfma_f32_16x16x32_bf16 v[128:131], a[80:83], v[104:107], v[128:131]
    buffer_load_dwordx4 v16, s[52:55], s79 offen offset:2048 lds
    ds_read_b128 a[116:119], v8 offset:9984
    v_mfma_f32_16x16x32_bf16 v[132:135], a[84:87], v[100:103], v[132:135]
    ds_read_b128 a[120:123], v8 offset:11008
    ds_read_b128 a[124:127], v8 offset:12032
    v_mfma_f32_16x16x32_bf16 v[136:139], a[84:87], v[104:107], v[136:139]
    ds_read_b128 v[116:119], v23 offset:12288
    ds_read_b128 v[120:123], v23 offset:14336
    v_mfma_f32_16x16x32_bf16 v[140:143], a[88:91], v[100:103], v[140:143]
    v_mov_b32 v10, 0
    global_load_dwordx2 v[224:225], v10, s[34:35] sc1
    v_mfma_f32_16x16x32_bf16 v[144:147], a[88:91], v[104:107], v[144:147]
    buffer_load_dwordx4 v17, s[52:55], s79 offen offset:3072 lds
    s_add_u32 s76, s76, 1
    s_cmp_eq_u32 s76, 7
    s_cselect_b32 s76, 0, s76
    v_mfma_f32_16x16x32_bf16 v[148:151], a[92:95], v[100:103], v[148:151]
    v_mfma_f32_16x16x32_bf16 v[152:155], a[92:95], v[104:107], v[152:155]
    s_waitcnt lgkmcnt(0)
    v_mfma_f32_16x16x32_bf16 v[124:127], a[96:99], v[108:111], v[124:127]
    s_lshr_b32 s76, s40, 3
    s_mul_i32 s76, s76, 4
    v_mfma_f32_16x16x32_bf16 v[128:131], a[96:99], v[112:115], v[128:131]
    s_add_u32 m0, s78, 8192
    s_mul_i32 s79, s76, 114688
    v_mfma_f32_16x16x32_bf16 v[132:135], a[100:103], v[108:111], v[132:135]
    s_lshl_b32 s71, s77, 13
    v_add_u32 v1, s71, v6
    v_mfma_f32_16x16x32_bf16 v[136:139], a[100:103], v[112:115], v[136:139]
    v_add_u32 v8, s71, v7
    s_add_u32 s77, s77, 1
    v_mfma_f32_16x16x32_bf16 v[140:143], a[104:107], v[108:111], v[140:143]
    s_cmp_eq_u32 s77, 7
    s_cselect_b32 s77, 0, s77
    v_mfma_f32_16x16x32_bf16 v[144:147], a[104:107], v[112:115], v[144:147]
    buffer_load_dwordx4 v18, s[56:59], s79 offen lds
    s_waitcnt vmcnt(10)
    v_mfma_f32_16x16x32_bf16 v[148:151], a[108:111], v[108:111], v[148:151]
    ds_read_b128 a[128:131], v1 offset:4864
    ds_read_b128 a[132:135], v1 offset:5888
    v_mfma_f32_16x16x32_bf16 v[152:155], a[108:111], v[112:115], v[152:155]
    ds_read_b128 a[136:139], v1 offset:6912
    ds_read_b128 a[140:143], v1 offset:7936
    v_mfma_f32_16x16x32_bf16 v[124:127], a[112:115], v[116:119], v[124:127]
    ds_read_b128 v[92:95], v22 offset:16384
    ds_read_b128 v[96:99], v22 offset:18432
    v_mfma_f32_16x16x32_bf16 v[128:131], a[112:115], v[120:123], v[128:131]
    buffer_load_dwordx4 v19, s[56:59], s79 offen offset:1024 lds
    ds_read_b128 a[144:147], v8 offset:8960
    v_mfma_f32_16x16x32_bf16 v[132:135], a[116:119], v[116:119], v[132:135]
    ds_read_b128 a[148:151], v8 offset:9984
    ds_read_b128 a[152:155], v8 offset:11008
    v_mfma_f32_16x16x32_bf16 v[136:139], a[116:119], v[120:123], v[136:139]
    ds_read_b128 a[156:159], v8 offset:12032
    ds_read_b128 v[100:103], v23 offset:16384
    v_mfma_f32_16x16x32_bf16 v[140:143], a[120:123], v[116:119], v[140:143]
    ds_read_b128 v[104:107], v23 offset:18432
    v_mfma_f32_16x16x32_bf16 v[144:147], a[120:123], v[120:123], v[144:147]
    buffer_load_dwordx4 v20, s[56:59], s79 offen offset:2048 lds
    v_mfma_f32_16x16x32_bf16 v[148:151], a[124:127], v[116:119], v[148:151]
    v_mfma_f32_16x16x32_bf16 v[152:155], a[124:127], v[120:123], v[152:155]
    buffer_load_dwordx4 v21, s[56:59], s79 offen offset:3072 lds
    s_add_u32 s76, s76, 1
    s_cmp_eq_u32 s76, 14
    s_cselect_b32 s76, 0, s76
    s_waitcnt lgkmcnt(0)
    v_mfma_f32_16x16x32_bf16 v[124:127], a[128:131], v[92:95], v[124:127]
    s_add_u32 m0, s78, 12288
    s_mul_i32 s79, s76, 114688
    v_mfma_f32_16x16x32_bf16 v[128:131], a[128:131], v[96:99], v[128:131]
    buffer_load_dwordx4 v18, s[56:59], s79 offen lds
    s_lshl_b32 s71, s77, 13
    v_mfma_f32_16x16x32_bf16 v[132:135], a[132:135], v[92:95], v[132:135]
    v_add_u32 v1, s71, v6
    v_add_u32 v8, s71, v7
    v_mfma_f32_16x16x32_bf16 v[136:139], a[132:135], v[96:99], v[136:139]
    s_add_u32 s77, s77, 1
    s_cmp_eq_u32 s77, 7
    v_mfma_f32_16x16x32_bf16 v[140:143], a[136:139], v[92:95], v[140:143]
    s_cselect_b32 s77, 0, s77
    s_waitcnt vmcnt(10)
    v_mfma_f32_16x16x32_bf16 v[144:147], a[136:139], v[96:99], v[144:147]
    buffer_load_dwordx4 v19, s[56:59], s79 offen offset:1024 lds
    ds_read_b128 a[160:163], v1 offset:4864
    v_mfma_f32_16x16x32_bf16 v[148:151], a[140:143], v[92:95], v[148:151]
    ds_read_b128 a[164:167], v1 offset:5888
    ds_read_b128 a[168:171], v1 offset:6912
    v_mfma_f32_16x16x32_bf16 v[152:155], a[140:143], v[96:99], v[152:155]
    ds_read_b128 a[172:175], v1 offset:7936
    ds_read_b128 v[108:111], v22 offset:0
    v_mfma_f32_16x16x32_bf16 v[124:127], a[144:147], v[100:103], v[124:127]
    ds_read_b128 v[112:115], v22 offset:2048
    ds_read_b128 a[176:179], v8 offset:8960
    v_mfma_f32_16x16x32_bf16 v[128:131], a[144:147], v[104:107], v[128:131]
    buffer_load_dwordx4 v20, s[56:59], s79 offen offset:2048 lds
    ds_read_b128 a[180:183], v8 offset:9984
    v_mfma_f32_16x16x32_bf16 v[132:135], a[148:151], v[100:103], v[132:135]
    ds_read_b128 a[184:187], v8 offset:11008
    ds_read_b128 a[188:191], v8 offset:12032
    v_mfma_f32_16x16x32_bf16 v[136:139], a[148:151], v[104:107], v[136:139]
    ds_read_b128 v[116:119], v23 offset:0
    ds_read_b128 v[120:123], v23 offset:2048
    v_mfma_f32_16x16x32_bf16 v[140:143], a[152:155], v[100:103], v[140:143]
    v_mfma_f32_16x16x32_bf16 v[144:147], a[152:155], v[104:107], v[144:147]
    buffer_load_dwordx4 v21, s[56:59], s79 offen offset:3072 lds
    s_add_u32 s76, s76, 1
    s_cmp_eq_u32 s76, 14
    s_cselect_b32 s76, 0, s76
    v_mfma_f32_16x16x32_bf16 v[148:151], a[156:159], v[100:103], v[148:151]
    v_mfma_f32_16x16x32_bf16 v[152:155], a[156:159], v[104:107], v[152:155]
    s_waitcnt lgkmcnt(0)
    v_mfma_f32_16x16x32_bf16 v[124:127], a[160:163], v[108:111], v[124:127]
    s_add_u32 m0, s78, 16384
    s_mul_i32 s79, s76, 114688
    v_mfma_f32_16x16x32_bf16 v[128:131], a[160:163], v[112:115], v[128:131]
    buffer_load_dwordx4 v18, s[56:59], s79 offen lds
    s_lshl_b32 s71, s77, 13
    v_mfma_f32_16x16x32_bf16 v[132:135], a[164:167], v[108:111], v[132:135]
    v_add_u32 v1, s71, v6
    v_add_u32 v8, s71, v7
    v_mfma_f32_16x16x32_bf16 v[136:139], a[164:167], v[112:115], v[136:139]
    s_add_u32 s77, s77, 1
    s_cmp_eq_u32 s77, 7
    v_mfma_f32_16x16x32_bf16 v[140:143], a[168:171], v[108:111], v[140:143]
    s_cselect_b32 s77, 0, s77
    s_waitcnt vmcnt(9)
    v_mfma_f32_16x16x32_bf16 v[144:147], a[168:171], v[112:115], v[144:147]
    buffer_load_dwordx4 v19, s[56:59], s79 offen offset:1024 lds
    ds_read_b128 a[192:195], v1 offset:4864
    v_mfma_f32_16x16x32_bf16 v[148:151], a[172:175], v[108:111], v[148:151]
    ds_read_b128 a[196:199], v1 offset:5888
    ds_read_b128 a[200:203], v1 offset:6912
    v_mfma_f32_16x16x32_bf16 v[152:155], a[172:175], v[112:115], v[152:155]
    ds_read_b128 a[204:207], v1 offset:7936
    ds_read_b128 v[92:95], v22 offset:4096
    v_mfma_f32_16x16x32_bf16 v[124:127], a[176:179], v[116:119], v[124:127]
    ds_read_b128 v[96:99], v22 offset:6144
    ds_read_b128 a[208:211], v8 offset:8960
    v_mfma_f32_16x16x32_bf16 v[128:131], a[176:179], v[120:123], v[128:131]
    buffer_load_dwordx4 v20, s[56:59], s79 offen offset:2048 lds
    ds_read_b128 a[212:215], v8 offset:9984
    v_mfma_f32_16x16x32_bf16 v[132:135], a[180:183], v[116:119], v[132:135]
    ds_read_b128 a[216:219], v8 offset:11008
    ds_read_b128 a[220:223], v8 offset:12032
    v_mfma_f32_16x16x32_bf16 v[136:139], a[180:183], v[120:123], v[136:139]
    ds_read_b128 v[100:103], v23 offset:4096
    ds_read_b128 v[104:107], v23 offset:6144
    v_mfma_f32_16x16x32_bf16 v[140:143], a[184:187], v[116:119], v[140:143]
    v_mfma_f32_16x16x32_bf16 v[144:147], a[184:187], v[120:123], v[144:147]
    buffer_load_dwordx4 v21, s[56:59], s79 offen offset:3072 lds
    s_add_u32 s76, s76, 1
    s_cmp_eq_u32 s76, 14
    s_cselect_b32 s76, 0, s76
    v_mfma_f32_16x16x32_bf16 v[148:151], a[188:191], v[116:119], v[148:151]
    v_mfma_f32_16x16x32_bf16 v[152:155], a[188:191], v[120:123], v[152:155]
    s_waitcnt lgkmcnt(0)
    v_mfma_f32_16x16x32_bf16 v[124:127], a[192:195], v[92:95], v[124:127]
    s_add_u32 m0, s78, 0
    s_mul_i32 s79, s76, 114688
    v_mfma_f32_16x16x32_bf16 v[128:131], a[192:195], v[96:99], v[128:131]
    buffer_load_dwordx4 v18, s[56:59], s79 offen lds
    s_waitcnt vmcnt(9)
    v_mfma_f32_16x16x32_bf16 v[132:135], a[196:199], v[92:95], v[132:135]
    ds_read_b64_tr_b16 v[108:109], v24 offset:8192
    ds_read_b64_tr_b16 v[110:111], v24 offset:8704
    v_mfma_f32_16x16x32_bf16 v[136:139], a[196:199], v[96:99], v[136:139]
    ds_read_b64_tr_b16 v[112:113], v25 offset:8192
    ds_read_b64_tr_b16 v[114:115], v25 offset:8704
    v_mfma_f32_16x16x32_bf16 v[140:143], a[200:203], v[92:95], v[140:143]
    ds_read_b64_tr_b16 v[116:117], v26 offset:8192
    ds_read_b64_tr_b16 v[118:119], v26 offset:8704
    v_mfma_f32_16x16x32_bf16 v[144:147], a[200:203], v[96:99], v[144:147]
    buffer_load_dwordx4 v19, s[56:59], s79 offen offset:1024 lds
    ds_read_b64_tr_b16 v[120:121], v27 offset:8192
    v_mfma_f32_16x16x32_bf16 v[148:151], a[204:207], v[92:95], v[148:151]
    ds_read_b64_tr_b16 v[122:123], v27 offset:8704
    v_mfma_f32_16x16x32_bf16 v[152:155], a[204:207], v[96:99], v[152:155]
    v_mfma_f32_16x16x32_bf16 v[124:127], a[208:211], v[100:103], v[124:127]
    v_mfma_f32_16x16x32_bf16 v[128:131], a[208:211], v[104:107], v[128:131]
    buffer_load_dwordx4 v20, s[56:59], s79 offen offset:2048 lds
    v_mfma_f32_16x16x32_bf16 v[132:135], a[212:215], v[100:103], v[132:135]
    v_mfma_f32_16x16x32_bf16 v[136:139], a[212:215], v[104:107], v[136:139]
    v_mfma_f32_16x16x32_bf16 v[140:143], a[216:219], v[100:103], v[140:143]
    v_mfma_f32_16x16x32_bf16 v[144:147], a[216:219], v[104:107], v[144:147]
    buffer_load_dwordx4 v21, s[56:59], s79 offen offset:3072 lds
    s_add_u32 s76, s76, 1
    s_cmp_eq_u32 s76, 14
    s_cselect_b32 s76, 0, s76
    v_mfma_f32_16x16x32_bf16 v[148:151], a[220:223], v[100:103], v[148:151]
    v_mfma_f32_16x16x32_bf16 v[152:155], a[220:223], v[104:107], v[152:155]
    v_pk_mul_f32 v[242:243], v[46:47], v[226:227] op_sel:[0,0] op_sel_hi:[1,0]
    v_pk_mul_f32 v[244:245], v[124:125], v[242:243] op_sel:[0,0] op_sel_hi:[0,1]
    v_pk_fma_f32 v[60:61], v[128:129], v[242:243], v[244:245] op_sel:[0,1,0] op_sel_hi:[0,0,1] neg_lo:[0,1,0]
    v_pk_mul_f32 v[246:247], v[46:47], v[226:227] op_sel:[0,1] op_sel_hi:[1,1]
    v_pk_mul_f32 v[248:249], v[124:125], v[246:247] op_sel:[1,0] op_sel_hi:[1,1]
    v_pk_fma_f32 v[62:63], v[128:129], v[246:247], v[248:249] op_sel:[1,1,0] op_sel_hi:[1,0,1] neg_lo:[0,1,0]
    v_pk_mul_f32 v[242:243], v[46:47], v[228:229] op_sel:[0,0] op_sel_hi:[1,0]
    v_pk_mul_f32 v[244:245], v[126:127], v[242:243] op_sel:[0,0] op_sel_hi:[0,1]
    v_pk_fma_f32 v[64:65], v[130:131], v[242:243], v[244:245] op_sel:[0,1,0] op_sel_hi:[0,0,1] neg_lo:[0,1,0]
    v_pk_mul_f32 v[246:247], v[46:47], v[228:229] op_sel:[0,1] op_sel_hi:[1,1]
    v_pk_mul_f32 v[248:249], v[126:127], v[246:247] op_sel:[1,0] op_sel_hi:[1,1]
    v_pk_fma_f32 v[66:67], v[130:131], v[246:247], v[248:249] op_sel:[1,1,0] op_sel_hi:[1,0,1] neg_lo:[0,1,0]
    v_pk_mul_f32 v[242:243], v[46:47], v[230:231] op_sel:[0,0] op_sel_hi:[1,0]
    v_pk_mul_f32 v[244:245], v[132:133], v[242:243] op_sel:[0,0] op_sel_hi:[0,1]
    v_pk_fma_f32 v[68:69], v[136:137], v[242:243], v[244:245] op_sel:[0,1,0] op_sel_hi:[0,0,1] neg_lo:[0,1,0]
    v_pk_mul_f32 v[246:247], v[46:47], v[230:231] op_sel:[0,1] op_sel_hi:[1,1]
    v_pk_mul_f32 v[248:249], v[132:133], v[246:247] op_sel:[1,0] op_sel_hi:[1,1]
    v_pk_fma_f32 v[70:71], v[136:137], v[246:247], v[248:249] op_sel:[1,1,0] op_sel_hi:[1,0,1] neg_lo:[0,1,0]
    v_pk_mul_f32 v[242:243], v[46:47], v[232:233] op_sel:[0,0] op_sel_hi:[1,0]
    v_pk_mul_f32 v[244:245], v[134:135], v[242:243] op_sel:[0,0] op_sel_hi:[0,1]
    v_pk_fma_f32 v[72:73], v[138:139], v[242:243], v[244:245] op_sel:[0,1,0] op_sel_hi:[0,0,1] neg_lo:[0,1,0]
    v_pk_mul_f32 v[246:247], v[46:47], v[232:233] op_sel:[0,1] op_sel_hi:[1,1]
    v_pk_mul_f32 v[248:249], v[134:135], v[246:247] op_sel:[1,0] op_sel_hi:[1,1]
    v_pk_fma_f32 v[74:75], v[138:139], v[246:247], v[248:249] op_sel:[1,1,0] op_sel_hi:[1,0,1] neg_lo:[0,1,0]
    v_pk_mul_f32 v[242:243], v[46:47], v[234:235] op_sel:[0,0] op_sel_hi:[1,0]
    v_pk_mul_f32 v[244:245], v[140:141], v[242:243] op_sel:[0,0] op_sel_hi:[0,1]
    v_pk_fma_f32 v[76:77], v[144:145], v[242:243], v[244:245] op_sel:[0,1,0] op_sel_hi:[0,0,1] neg_lo:[0,1,0]
    v_pk_mul_f32 v[246:247], v[46:47], v[234:235] op_sel:[0,1] op_sel_hi:[1,1]
    v_pk_mul_f32 v[248:249], v[140:141], v[246:247] op_sel:[1,0] op_sel_hi:[1,1]
    v_pk_fma_f32 v[78:79], v[144:145], v[246:247], v[248:249] op_sel:[1,1,0] op_sel_hi:[1,0,1] neg_lo:[0,1,0]
    v_pk_mul_f32 v[242:243], v[46:47], v[236:237] op_sel:[0,0] op_sel_hi:[1,0]
    v_pk_mul_f32 v[244:245], v[142:143], v[242:243] op_sel:[0,0] op_sel_hi:[0,1]
    v_pk_fma_f32 v[80:81], v[146:147], v[242:243], v[244:245] op_sel:[0,1,0] op_sel_hi:[0,0,1] neg_lo:[0,1,0]
    v_pk_mul_f32 v[246:247], v[46:47], v[236:237] op_sel:[0,1] op_sel_hi:[1,1]
    v_pk_mul_f32 v[248:249], v[142:143], v[246:247] op_sel:[1,0] op_sel_hi:[1,1]
    v_pk_fma_f32 v[82:83], v[146:147], v[246:247], v[248:249] op_sel:[1,1,0] op_sel_hi:[1,0,1] neg_lo:[0,1,0]
    v_pk_mul_f32 v[242:243], v[46:47], v[238:239] op_sel:[0,0] op_sel_hi:[1,0]
    v_pk_mul_f32 v[244:245], v[148:149], v[242:243] op_sel:[0,0] op_sel_hi:[0,1]
    v_pk_fma_f32 v[84:85], v[152:153], v[242:243], v[244:245] op_sel:[0,1,0] op_sel_hi:[0,0,1] neg_lo:[0,1,0]
    v_pk_mul_f32 v[246:247], v[46:47], v[238:239] op_sel:[0,1] op_sel_hi:[1,1]
    v_pk_mul_f32 v[248:249], v[148:149], v[246:247] op_sel:[1,0] op_sel_hi:[1,1]
    v_pk_fma_f32 v[86:87], v[152:153], v[246:247], v[248:249] op_sel:[1,1,0] op_sel_hi:[1,0,1] neg_lo:[0,1,0]
    v_pk_mul_f32 v[242:243], v[46:47], v[240:241] op_sel:[0,0] op_sel_hi:[1,0]
    v_pk_mul_f32 v[244:245], v[150:151], v[242:243] op_sel:[0,0] op_sel_hi:[0,1]
    v_pk_fma_f32 v[88:89], v[154:155], v[242:243], v[244:245] op_sel:[0,1,0] op_sel_hi:[0,0,1] neg_lo:[0,1,0]
    v_pk_mul_f32 v[246:247], v[46:47], v[240:241] op_sel:[0,1] op_sel_hi:[1,1]
    v_pk_mul_f32 v[248:249], v[150:151], v[246:247] op_sel:[1,0] op_sel_hi:[1,1]
    v_pk_fma_f32 v[90:91], v[154:155], v[246:247], v[248:249] op_sel:[1,1,0] op_sel_hi:[1,0,1] neg_lo:[0,1,0]
    v_pk_fma_f32 v[244:245], v[60:61], v[44:45], v[62:63] op_sel:[0,0,0] op_sel_hi:[1,0,1]
    v_pk_fma_f32 v[242:243], v[60:61], v[44:45], v[244:245] op_sel:[1,1,0] op_sel_hi:[0,1,1] neg_lo:[0,1,0]
    v_pk_fma_f32 v[244:245], v[242:243], v[44:45], v[64:65] op_sel:[0,0,0] op_sel_hi:[1,0,1]
    v_pk_fma_f32 v[242:243], v[242:243], v[44:45], v[244:245] op_sel:[1,1,0] op_sel_hi:[0,1,1] neg_lo:[0,1,0]
    v_pk_fma_f32 v[244:245], v[242:243], v[44:45], v[66:67] op_sel:[0,0,0] op_sel_hi:[1,0,1]
    v_pk_fma_f32 v[242:243], v[242:243], v[44:45], v[244:245] op_sel:[1,1,0] op_sel_hi:[0,1,1] neg_lo:[0,1,0]
    v_pk_fma_f32 v[244:245], v[242:243], v[44:45], v[68:69] op_sel:[0,0,0] op_sel_hi:[1,0,1]
    v_pk_fma_f32 v[242:243], v[242:243], v[44:45], v[244:245] op_sel:[1,1,0] op_sel_hi:[0,1,1] neg_lo:[0,1,0]
    v_pk_fma_f32 v[244:245], v[242:243], v[44:45], v[70:71] op_sel:[0,0,0] op_sel_hi:[1,0,1]
    v_pk_fma_f32 v[242:243], v[242:243], v[44:45], v[244:245] op_sel:[1,1,0] op_sel_hi:[0,1,1] neg_lo:[0,1,0]
    v_pk_fma_f32 v[244:245], v[242:243], v[44:45], v[72:73] op_sel:[0,0,0] op_sel_hi:[1,0,1]
    v_pk_fma_f32 v[242:243], v[242:243], v[44:45], v[244:245] op_sel:[1,1,0] op_sel_hi:[0,1,1] neg_lo:[0,1,0]
    v_pk_fma_f32 v[244:245], v[242:243], v[44:45], v[74:75] op_sel:[0,0,0] op_sel_hi:[1,0,1]
    v_pk_fma_f32 v[242:243], v[242:243], v[44:45], v[244:245] op_sel:[1,1,0] op_sel_hi:[0,1,1] neg_lo:[0,1,0]
    v_pk_fma_f32 v[244:245], v[242:243], v[44:45], v[76:77] op_sel:[0,0,0] op_sel_hi:[1,0,1]
    v_pk_fma_f32 v[242:243], v[242:243], v[44:45], v[244:245] op_sel:[1,1,0] op_sel_hi:[0,1,1] neg_lo:[0,1,0]
    v_pk_fma_f32 v[244:245], v[242:243], v[44:45], v[78:79] op_sel:[0,0,0] op_sel_hi:[1,0,1]
    v_pk_fma_f32 v[242:243], v[242:243], v[44:45], v[244:245] op_sel:[1,1,0] op_sel_hi:[0,1,1] neg_lo:[0,1,0]
    v_pk_fma_f32 v[244:245], v[242:243], v[44:45], v[80:81] op_sel:[0,0,0] op_sel_hi:[1,0,1]
    v_pk_fma_f32 v[242:243], v[242:243], v[44:45], v[244:245] op_sel:[1,1,0] op_sel_hi:[0,1,1] neg_lo:[0,1,0]
    v_pk_fma_f32 v[244:245], v[242:243], v[44:45], v[82:83] op_sel:[0,0,0] op_sel_hi:[1,0,1]
    v_pk_fma_f32 v[242:243], v[242:243], v[44:45], v[244:245] op_sel:[1,1,0] op_sel_hi:[0,1,1] neg_lo:[0,1,0]
    v_pk_fma_f32 v[244:245], v[242:243], v[44:45], v[84:85] op_sel:[0,0,0] op_sel_hi:[1,0,1]
    v_pk_fma_f32 v[242:243], v[242:243], v[44:45], v[244:245] op_sel:[1,1,0] op_sel_hi:[0,1,1] neg_lo:[0,1,0]
    v_pk_fma_f32 v[244:245], v[242:243], v[44:45], v[86:87] op_sel:[0,0,0] op_sel_hi:[1,0,1]
    v_pk_fma_f32 v[242:243], v[242:243], v[44:45], v[244:245] op_sel:[1,1,0] op_sel_hi:[0,1,1] neg_lo:[0,1,0]
    v_pk_fma_f32 v[244:245], v[242:243], v[44:45], v[88:89] op_sel:[0,0,0] op_sel_hi:[1,0,1]
    v_pk_fma_f32 v[242:243], v[242:243], v[44:45], v[244:245] op_sel:[1,1,0] op_sel_hi:[0,1,1] neg_lo:[0,1,0]
    v_pk_fma_f32 v[244:245], v[242:243], v[44:45], v[90:91] op_sel:[0,0,0] op_sel_hi:[1,0,1]
    v_pk_fma_f32 v[242:243], v[242:243], v[44:45], v[244:245] op_sel:[1,1,0] op_sel_hi:[0,1,1] neg_lo:[0,1,0]
    s_lshl_b32 s68, s3, 10
    s_add_u32 s68, s68, 768
    v_lshl_add_u32 v15, v4, 3, s68
    v_lshl_add_u32 v14, v5, 7, v15
    ds_write_b64 v14, v[242:243]
    s_waitcnt lgkmcnt(0)
    ds_read_b64 v[226:227], v15 offset:0
    ds_read_b64 v[228:229], v15 offset:128
    ds_read_b64 v[230:231], v15 offset:256
    ds_read_b64 v[232:233], v15 offset:384
    s_waitcnt lgkmcnt(0)
    s_nop 0
    v_pk_fma_f32 v[244:245], v[226:227], v[48:49], v[228:229] op_sel:[0,0,0] op_sel_hi:[1,0,1]
    v_pk_fma_f32 v[228:229], v[226:227], v[48:49], v[244:245] op_sel:[1,1,0] op_sel_hi:[0,1,1] neg_lo:[0,1,0]
    v_pk_fma_f32 v[244:245], v[228:229], v[48:49], v[230:231] op_sel:[0,0,0] op_sel_hi:[1,0,1]
    v_pk_fma_f32 v[230:231], v[228:229], v[48:49], v[244:245] op_sel:[1,1,0] op_sel_hi:[0,1,1] neg_lo:[0,1,0]
    v_pk_fma_f32 v[244:245], v[230:231], v[48:49], v[232:233] op_sel:[0,0,0] op_sel_hi:[1,0,1]
    v_pk_fma_f32 v[232:233], v[230:231], v[48:49], v[244:245] op_sel:[1,1,0] op_sel_hi:[0,1,1] neg_lo:[0,1,0]
    s_waitcnt vmcnt(17)
    v_cmp_ne_u32 vcc, 0, v224
    s_cbranch_vccnz KP_NONCE_OK
    s_mov_b32 s82, 262144
KP_NONCE_LOOP:
    s_sub_u32 s82, s82, 1
    s_cmp_eq_u32 s82, 0
    s_cbranch_scc1 KP_NONCE_OK
    s_sleep 1
    v_mov_b32 v9, 0
    global_load_dwordx2 v[224:225], v9, s[34:35] sc1
    s_waitcnt vmcnt(0)
    v_cmp_ne_u32 vcc, 0, v224
    s_cbranch_vccz KP_NONCE_LOOP
KP_NONCE_OK:
    v_mov_b32 v244, v232
    v_mov_b32 v245, v233
    v_mov_b32 v246, v224
    v_mov_b32 v247, v225
    s_mul_i32 s68, s40, 7
    s_add_u32 s68, s68, s41
    s_lshl_b32 s68, s68, 10
    s_lshl_b32 s69, s3, 8
    s_add_u32 s68, s68, s69
    v_lshl_add_u32 v13, v4, 4, s68
    s_mov_b64 exec, 0xffff
    buffer_store_dwordx4 v[244:247], v13, s[64:67], 0 offen sc1
    s_getreg_b32 s9, hwreg(HW_REG_XCC_ID)
    v_mov_b32 v248, v224
    v_mov_b32 v249, v225
    v_mov_b32 v250, s9
    v_mov_b32 v251, 0
    s_lshl_b32 s68, s40, 7
    s_lshl_b32 s69, s41, 4
    s_add_u32 s68, s68, s69
    s_add_u32 s68, s68, 13684736
    v_mov_b32 v9, 0
    s_mov_b64 exec, 1
    buffer_store_dwordx4 v[248:251], v9, s[60:63], s68 offen sc1
    s_mov_b64 exec, -1
    s_barrier
    s_waitcnt lgkmcnt(5)
    v_mfma_f32_16x16x32_bf16 v[156:159], v[108:111], a[0:3], 0
    s_add_u32 m0, s78, 4096
    s_mul_i32 s79, s76, 114688
    s_waitcnt vmcnt(10)
    ds_read_b64_tr_b16 v[92:93], v24 offset:12288
    v_mfma_f32_16x16x32_bf16 v[160:163], v[108:111], a[4:7], 0
    buffer_load_dwordx4 v18, s[56:59], s79 offen lds
    ds_read_b64_tr_b16 v[94:95], v24 offset:12800
    ds_read_b64_tr_b16 v[96:97], v25 offset:12288
    v_mfma_f32_16x16x32_bf16 v[164:167], v[108:111], a[8:11], 0
    ds_read_b64_tr_b16 v[98:99], v25 offset:12800
    ds_read_b64_tr_b16 v[100:101], v26 offset:12288
    v_mfma_f32_16x16x32_bf16 v[168:171], v[108:111], a[12:15], 0
    ds_read_b64_tr_b16 v[102:103], v26 offset:12800
    ds_read_b64_tr_b16 v[104:105], v27 offset:12288
    v_mfma_f32_16x16x32_bf16 v[172:175], v[112:115], a[0:3], 0
    ds_read_b64_tr_b16 v[106:107], v27 offset:12800
    v_mov_b32 v58, 0
    v_mfma_f32_16x16x32_bf16 v[176:179], v[112:115], a[4:7], 0
    buffer_load_dwordx4 v19, s[56:59], s79 offen offset:1024 lds
    v_mov_b32 v59, 0
    v_mov_b32 v248, 1.0
    v_mfma_f32_16x16x32_bf16 v[180:183], v[112:115], a[8:11], 0
    v_mov_b32 v249, 0
    v_cmp_eq_u32 vcc, 1, v5
    v_mfma_f32_16x16x32_bf16 v[184:187], v[112:115], a[12:15], 0
    s_nop 1
    v_cndmask_b32 v58, v58, v226, vcc
    v_mfma_f32_16x16x32_bf16 v[188:191], v[116:119], a[0:3], 0
    v_cndmask_b32 v59, v59, v227, vcc
    v_cndmask_b32 v248, v248, v48, vcc
    v_mfma_f32_16x16x32_bf16 v[192:195], v[116:119], a[4:7], 0
    buffer_load_dwordx4 v20, s[56:59], s79 offen offset:2048 lds
    v_cndmask_b32 v249, v249, v49, vcc
    v_cmp_eq_u32 vcc, 2, v5
    v_mfma_f32_16x16x32_bf16 v[196:199], v[116:119], a[8:11], 0
    s_nop 1
    v_cndmask_b32 v58, v58, v228, vcc
    v_mfma_f32_16x16x32_bf16 v[200:203], v[116:119], a[12:15], 0
    v_cndmask_b32 v59, v59, v229, vcc
    v_cndmask_b32 v248, v248, v50, vcc
    v_mfma_f32_16x16x32_bf16 v[204:207], v[120:123], a[0:3], 0
    v_cndmask_b32 v249, v249, v51, vcc
    v_cmp_eq_u32 vcc, 3, v5
    v_mfma_f32_16x16x32_bf16 v[208:211], v[120:123], a[4:7], 0
    buffer_load_dwordx4 v21, s[56:59], s79 offen offset:3072 lds
    s_add_u32 s76, s76, 1
    s_cmp_eq_u32 s76, 14
    s_cselect_b32 s76, 0, s76
    s_nop 1
    v_cndmask_b32 v58, v58, v230, vcc
    v_mfma_f32_16x16x32_bf16 v[212:215], v[120:123], a[8:11], 0
    v_cndmask_b32 v59, v59, v231, vcc
    v_cndmask_b32 v248, v248, v52, vcc
    v_mfma_f32_16x16x32_bf16 v[216:219], v[120:123], a[12:15], 0
    v_cndmask_b32 v249, v249, v53, vcc
    v_mov_b32 v50, v248
    s_waitcnt lgkmcnt(0)
    v_mfma_f32_16x16x32_bf16 v[156:159], v[92:95], a[16:19], v[156:159]
    s_add_u32 m0, s78, 8192
    s_mul_i32 s79, s76, 114688
    v_mfma_f32_16x16x32_bf16 v[160:163], v[92:95], a[20:23], v[160:163]
    buffer_load_dwordx4 v18, s[56:59], s79 offen lds
    s_waitcnt vmcnt(11)
    v_mfma_f32_16x16x32_bf16 v[164:167], v[92:95], a[24:27], v[164:167]
    ds_read_b64_tr_b16 v[108:109], v24 offset:16384
    ds_read_b64_tr_b16 v[110:111], v24 offset:16896
    v_mfma_f32_16x16x32_bf16 v[168:171], v[92:95], a[28:31], v[168:171]
    ds_read_b64_tr_b16 v[112:113], v25 offset:16384
    ds_read_b64_tr_b16 v[114:115], v25 offset:16896
    v_mfma_f32_16x16x32_bf16 v[172:175], v[96:99], a[16:19], v[172:175]
    ds_read_b64_tr_b16 v[116:117], v26 offset:16384
    ds_read_b64_tr_b16 v[118:119], v26 offset:16896
    v_mfma_f32_16x16x32_bf16 v[176:179], v[96:99], a[20:23], v[176:179]
    buffer_load_dwordx4 v19, s[56:59], s79 offen offset:1024 lds
    ds_read_b64_tr_b16 v[120:121], v27 offset:16384
    v_mfma_f32_16x16x32_bf16 v[180:183], v[96:99], a[24:27], v[180:183]
    ds_read_b64_tr_b16 v[122:123], v27 offset:16896
    v_mov_b32 v51, v249
    v_mfma_f32_16x16x32_bf16 v[184:187], v[96:99], a[28:31], v[184:187]
    v_add_u32 v9, 1, v5
    v_mul_u32_u24 v9, 7168, v9
    v_mfma_f32_16x16x32_bf16 v[188:191], v[100:103], a[16:19], v[188:191]
    v_sub_u32_e64 v226, v13, v9
    v_subrev_u32 v227, 28672, v226
    v_mfma_f32_16x16x32_bf16 v[192:195], v[100:103], a[20:23], v[192:195]
    buffer_load_dwordx4 v20, s[56:59], s79 offen offset:2048 lds
    v_subrev_u32 v228, 57344, v226
    v_mfma_f32_16x16x32_bf16 v[196:199], v[100:103], a[24:27], v[196:199]
    v_subrev_u32 v229, 86016, v226
    v_subrev_u32 v230, 114688, v226
    v_mfma_f32_16x16x32_bf16 v[200:203], v[100:103], a[28:31], v[200:203]
    v_subrev_u32 v231, 143360, v226
    v_subrev_u32 v232, 172032, v226
    v_mfma_f32_16x16x32_bf16 v[204:207], v[104:107], a[16:19], v[204:207]
    v_subrev_u32 v233, 200704, v226
    s_add_u32 s68, s40, 3
    v_mfma_f32_16x16x32_bf16 v[208:211], v[104:107], a[20:23], v[208:211]
    buffer_load_dwordx4 v21, s[56:59], s79 offen offset:3072 lds
    s_add_u32 s76, s76, 1
    s_cmp_eq_u32 s76, 14
    s_cselect_b32 s76, 0, s76
    v_mfma_f32_16x16x32_bf16 v[212:215], v[104:107], a[24:27], v[212:215]
    v_mfma_f32_16x16x32_bf16 v[216:219], v[104:107], a[28:31], v[216:219]
    s_waitcnt lgkmcnt(0)
    v_mfma_f32_16x16x32_bf16 v[156:159], v[108:111], a[32:35], v[156:159]
    s_add_u32 m0, s78, 12288
    s_mul_i32 s79, s76, 114688
    v_mfma_f32_16x16x32_bf16 v[160:163], v[108:111], a[36:39], v[160:163]
    buffer_load_dwordx4 v18, s[56:59], s79 offen lds
    s_waitcnt vmcnt(11)
    v_mfma_f32_16x16x32_bf16 v[164:167], v[108:111], a[40:43], v[164:167]
    ds_read_b64_tr_b16 v[92:93], v24 offset:0
    ds_read_b64_tr_b16 v[94:95], v24 offset:512
    v_mfma_f32_16x16x32_bf16 v[168:171], v[108:111], a[44:47], v[168:171]
    ds_read_b64_tr_b16 v[96:97], v25 offset:0
    ds_read_b64_tr_b16 v[98:99], v25 offset:512
    v_mfma_f32_16x16x32_bf16 v[172:175], v[112:115], a[32:35], v[172:175]
    ds_read_b64_tr_b16 v[100:101], v26 offset:0
    ds_read_b64_tr_b16 v[102:103], v26 offset:512
    v_mfma_f32_16x16x32_bf16 v[176:179], v[112:115], a[36:39], v[176:179]
    buffer_load_dwordx4 v19, s[56:59], s79 offen offset:1024 lds
    ds_read_b64_tr_b16 v[104:105], v27 offset:0
    v_mfma_f32_16x16x32_bf16 v[180:183], v[112:115], a[40:43], v[180:183]
    ds_read_b64_tr_b16 v[106:107], v27 offset:512
    v_sub_u32 v234, s68, v5
    v_mfma_f32_16x16x32_bf16 v[184:187], v[112:115], a[44:47], v[184:187]
    v_lshrrev_b32 v234, 2, v234
    s_lshl_b32 s68, s41, 9
    v_mfma_f32_16x16x32_bf16 v[188:191], v[116:119], a[32:35], v[188:191]
    s_lshl_b32 s69, s3, 7
    s_add_u32 s68, s68, s69
    v_mfma_f32_16x16x32_bf16 v[192:195], v[116:119], a[36:39], v[192:195]
    buffer_load_dwordx4 v20, s[56:59], s79 offen offset:2048 lds
    v_lshl_add_u32 v10, v5, 3, s68
    v_mfma_f32_16x16x32_bf16 v[196:199], v[116:119], a[40:43], v[196:199]
    global_load_dwordx2 v[28:29], v10, s[26:27] offset:0
    global_load_dwordx2 v[30:31], v10, s[26:27] offset:32
    v_mfma_f32_16x16x32_bf16 v[200:203], v[116:119], a[44:47], v[200:203]
    global_load_dwordx2 v[32:33], v10, s[26:27] offset:64
    global_load_dwordx2 v[34:35], v10, s[26:27] offset:96
    v_mfma_f32_16x16x32_bf16 v[204:207], v[120:123], a[32:35], v[204:207]
    s_add_u32 s68, s3, 0
    s_and_b32 s68, s68, 3
    v_mfma_f32_16x16x32_bf16 v[208:211], v[120:123], a[36:39], v[208:211]
    buffer_load_dwordx4 v21, s[56:59], s79 offen offset:3072 lds
    s_add_u32 s76, s76, 1
    s_cmp_eq_u32 s76, 14
    s_cselect_b32 s76, 0, s76
    v_mfma_f32_16x16x32_bf16 v[212:215], v[120:123], a[40:43], v[212:215]
    v_mfma_f32_16x16x32_bf16 v[216:219], v[120:123], a[44:47], v[216:219]
    s_waitcnt lgkmcnt(0)
    v_mfma_f32_16x16x32_bf16 v[156:159], v[92:95], a[48:51], v[156:159]
    s_add_u32 m0, s78, 16384
    s_mul_i32 s79, s76, 114688
    v_mfma_f32_16x16x32_bf16 v[160:163], v[92:95], a[52:55], v[160:163]
    buffer_load_dwordx4 v18, s[56:59], s79 offen lds
    s_waitcnt vmcnt(13)
    v_mfma_f32_16x16x32_bf16 v[164:167], v[92:95], a[56:59], v[164:167]
    ds_read_b64_tr_b16 v[108:109], v24 offset:4096
    ds_read_b64_tr_b16 v[110:111], v24 offset:4608
    v_mfma_f32_16x16x32_bf16 v[168:171], v[92:95], a[60:63], v[168:171]
    ds_read_b64_tr_b16 v[112:113], v25 offset:4096
    ds_read_b64_tr_b16 v[114:115], v25 offset:4608
    v_mfma_f32_16x16x32_bf16 v[172:175], v[96:99], a[48:51], v[172:175]
    ds_read_b64_tr_b16 v[116:117], v26 offset:4096
    ds_read_b64_tr_b16 v[118:119], v26 offset:4608
    v_mfma_f32_16x16x32_bf16 v[176:179], v[96:99], a[52:55], v[176:179]
    buffer_load_dwordx4 v19, s[56:59], s79 offen offset:1024 lds
    ds_read_b64_tr_b16 v[120:121], v27 offset:4096
    v_mfma_f32_16x16x32_bf16 v[180:183], v[96:99], a[56:59], v[180:183]
    ds_read_b64_tr_b16 v[122:123], v27 offset:4608
    s_lshl_b32 s68, s68, 10
    v_mfma_f32_16x16x32_bf16 v[184:187], v[96:99], a[60:63], v[184:187]
    v_add_u32 v16, s68, v12
    s_add_u32 s68, s3, 1
    v_mfma_f32_16x16x32_bf16 v[188:191], v[100:103], a[48:51], v[188:191]
    s_and_b32 s68, s68, 3
    s_lshl_b32 s68, s68, 10
    v_mfma_f32_16x16x32_bf16 v[192:195], v[100:103], a[52:55], v[192:195]
    buffer_load_dwordx4 v20, s[56:59], s79 offen offset:2048 lds
    v_add_u32 v17, s68, v12
    v_mfma_f32_16x16x32_bf16 v[196:199], v[100:103], a[56:59], v[196:199]
    s_add_u32 s68, s3, 2
    s_and_b32 s68, s68, 3
    v_mfma_f32_16x16x32_bf16 v[200:203], v[100:103], a[60:63], v[200:203]
    s_lshl_b32 s68, s68, 10
    v_add_u32 v22, s68, v12
    v_mfma_f32_16x16x32_bf16 v[204:207], v[104:107], a[48:51], v[204:207]
    s_add_u32 s68, s3, 3
    s_and_b32 s68, s68, 3
    v_mfma_f32_16x16x32_bf16 v[208:211], v[104:107], a[52:55], v[208:211]
    buffer_load_dwordx4 v21, s[56:59], s79 offen offset:3072 lds
    s_add_u32 s76, s76, 1
    s_cmp_eq_u32 s76, 14
    s_cselect_b32 s76, 0, s76
    v_mfma_f32_16x16x32_bf16 v[212:215], v[104:107], a[56:59], v[212:215]
    v_mfma_f32_16x16x32_bf16 v[216:219], v[104:107], a[60:63], v[216:219]
    s_waitcnt lgkmcnt(0)
    v_mfma_f32_16x16x32_bf16 v[156:159], v[108:111], a[64:67], v[156:159]
    s_add_u32 m0, s78, 0
    s_mul_i32 s79, s76, 114688
    v_mfma_f32_16x16x32_bf16 v[160:163], v[108:111], a[68:71], v[160:163]
    buffer_load_dwordx4 v18, s[56:59], s79 offen lds
    s_waitcnt vmcnt(13)
    v_mfma_f32_16x16x32_bf16 v[164:167], v[108:111], a[72:75], v[164:167]
    ds_read_b64_tr_b16 v[92:93], v24 offset:8192
    ds_read_b64_tr_b16 v[94:95], v24 offset:8704
    v_mfma_f32_16x16x32_bf16 v[168:171], v[108:111], a[76:79], v[168:171]
    ds_read_b64_tr_b16 v[96:97], v25 offset:8192
    ds_read_b64_tr_b16 v[98:99], v25 offset:8704
    v_mfma_f32_16x16x32_bf16 v[172:175], v[112:115], a[64:67], v[172:175]
    ds_read_b64_tr_b16 v[100:101], v26 offset:8192
    ds_read_b64_tr_b16 v[102:103], v26 offset:8704
    v_mfma_f32_16x16x32_bf16 v[176:179], v[112:115], a[68:71], v[176:179]
    buffer_load_dwordx4 v19, s[56:59], s79 offen offset:1024 lds
    ds_read_b64_tr_b16 v[104:105], v27 offset:8192
    v_mfma_f32_16x16x32_bf16 v[180:183], v[112:115], a[72:75], v[180:183]
    ds_read_b64_tr_b16 v[106:107], v27 offset:8704
    s_lshl_b32 s68, s68, 10
    v_mfma_f32_16x16x32_bf16 v[184:187], v[112:115], a[76:79], v[184:187]
    v_add_u32 v23, s68, v12
    s_mul_i32 s39, s41, 344064
    v_mfma_f32_16x16x32_bf16 v[188:191], v[116:119], a[64:67], v[188:191]
    s_add_u32 s39, s39, 11010048
    s_mul_i32 s68, s3, 28672
    v_mfma_f32_16x16x32_bf16 v[192:195], v[116:119], a[68:71], v[192:195]
    buffer_load_dwordx4 v20, s[56:59], s79 offen offset:2048 lds
    s_add_u32 s68, s68, 229376
    v_mfma_f32_16x16x32_bf16 v[196:199], v[116:119], a[72:75], v[196:199]
    s_add_u32 s42, s81, s68
    s_add_u32 s43, s39, s68
    v_mfma_f32_16x16x32_bf16 v[200:203], v[116:119], a[76:79], v[200:203]
    s_mul_i32 s68, s3, 57344
    s_add_u32 s38, s81, s68
    v_mfma_f32_16x16x32_bf16 v[204:207], v[120:123], a[64:67], v[204:207]
    s_add_u32 s39, s39, s68
    v_min_u32 v1, 6, v0
    v_mfma_f32_16x16x32_bf16 v[208:211], v[120:123], a[68:71], v[208:211]
    buffer_load_dwordx4 v21, s[56:59], s79 offen offset:3072 lds
    s_add_u32 s76, s76, 1
    s_cmp_eq_u32 s76, 14
    s_cselect_b32 s76, 0, s76
    v_mfma_f32_16x16x32_bf16 v[212:215], v[120:123], a[72:75], v[212:215]
    v_mfma_f32_16x16x32_bf16 v[216:219], v[120:123], a[76:79], v[216:219]
    s_waitcnt lgkmcnt(0)
    v_mfma_f32_16x16x32_bf16 v[156:159], v[92:95], a[80:83], v[156:159]
    s_add_u32 m0, s78, 4096
    s_mul_i32 s79, s76, 114688
    v_mfma_f32_16x16x32_bf16 v[160:163], v[92:95], a[84:87], v[160:163]
    buffer_load_dwordx4 v18, s[56:59], s79 offen lds
    s_waitcnt vmcnt(9)
    v_mfma_f32_16x16x32_bf16 v[164:167], v[92:95], a[88:91], v[164:167]
    ds_read_b64_tr_b16 v[108:109], v24 offset:12288
    ds_read_b64_tr_b16 v[110:111], v24 offset:12800
    v_mfma_f32_16x16x32_bf16 v[168:171], v[92:95], a[92:95], v[168:171]
    ds_read_b64_tr_b16 v[112:113], v25 offset:12288
    ds_read_b64_tr_b16 v[114:115], v25 offset:12800
    v_mfma_f32_16x16x32_bf16 v[172:175], v[96:99], a[80:83], v[172:175]
    ds_read_b64_tr_b16 v[116:117], v26 offset:12288
    ds_read_b64_tr_b16 v[118:119], v26 offset:12800
    v_mfma_f32_16x16x32_bf16 v[176:179], v[96:99], a[84:87], v[176:179]
    buffer_load_dwordx4 v19, s[56:59], s79 offen offset:1024 lds
    ds_read_b64_tr_b16 v[120:121], v27 offset:12288
    v_mfma_f32_16x16x32_bf16 v[180:183], v[96:99], a[88:91], v[180:183]
    ds_read_b64_tr_b16 v[122:123], v27 offset:12800
    s_mul_i32 s68, s3, 56
    v_mfma_f32_16x16x32_bf16 v[184:187], v[96:99], a[92:95], v[184:187]
    v_lshl_add_u32 v1, v1, 3, s68
    s_lshr_b32 s68, s40, 3
    v_mfma_f32_16x16x32_bf16 v[188:191], v[100:103], a[80:83], v[188:191]
    s_mul_i32 s69, s68, 7
    s_add_u32 s69, s69, 1
    v_mfma_f32_16x16x32_bf16 v[192:195], v[100:103], a[84:87], v[192:195]
    buffer_load_dwordx4 v20, s[56:59], s79 offen offset:2048 lds
    s_lshr_b32 s69, s69, 1
    v_mfma_f32_16x16x32_bf16 v[196:199], v[100:103], a[88:91], v[196:199]
    s_lshl_b32 s70, s41, 1
    s_add_u32 s69, s69, s70
    v_mfma_f32_16x16x32_bf16 v[200:203], v[100:103], a[92:95], v[200:203]
    s_cmp_ge_u32 s69, 14
    s_cselect_b32 s70, 14, 0
    s_sub_u32 s4, s69, s70
    v_mfma_f32_16x16x32_bf16 v[204:207], v[104:107], a[80:83], v[204:207]
    s_lshl_b32 s68, s68, 1
    s_add_u32 s68, s68, s41
    v_mfma_f32_16x16x32_bf16 v[208:211], v[104:107], a[84:87], v[208:211]
    buffer_load_dwordx4 v21, s[56:59], s79 offen offset:3072 lds
    s_add_u32 s76, s76, 1
    s_cmp_eq_u32 s76, 14
    s_cselect_b32 s76, 0, s76
    v_mfma_f32_16x16x32_bf16 v[212:215], v[104:107], a[88:91], v[212:215]
    v_mfma_f32_16x16x32_bf16 v[216:219], v[104:107], a[92:95], v[216:219]
    s_waitcnt lgkmcnt(0)
    v_mfma_f32_16x16x32_bf16 v[156:159], v[108:111], a[96:99], v[156:159]
    s_add_u32 m0, s78, 8192
    s_mul_i32 s79, s76, 114688
    v_mfma_f32_16x16x32_bf16 v[160:163], v[108:111], a[100:103], v[160:163]
    buffer_load_dwordx4 v18, s[56:59], s79 offen lds
    s_waitcnt vmcnt(9)
    v_mfma_f32_16x16x32_bf16 v[164:167], v[108:111], a[104:107], v[164:167]
    ds_read_b64_tr_b16 v[92:93], v24 offset:16384
    ds_read_b64_tr_b16 v[94:95], v24 offset:16896
    v_mfma_f32_16x16x32_bf16 v[168:171], v[108:111], a[108:111], v[168:171]
    ds_read_b64_tr_b16 v[96:97], v25 offset:16384
    ds_read_b64_tr_b16 v[98:99], v25 offset:16896
    v_mfma_f32_16x16x32_bf16 v[172:175], v[112:115], a[96:99], v[172:175]
    ds_read_b64_tr_b16 v[100:101], v26 offset:16384
    ds_read_b64_tr_b16 v[102:103], v26 offset:16896
    v_mfma_f32_16x16x32_bf16 v[176:179], v[112:115], a[100:103], v[176:179]
    buffer_load_dwordx4 v19, s[56:59], s79 offen offset:1024 lds
    ds_read_b64_tr_b16 v[104:105], v27 offset:16384
    v_mfma_f32_16x16x32_bf16 v[180:183], v[112:115], a[104:107], v[180:183]
    ds_read_b64_tr_b16 v[106:107], v27 offset:16896
    s_cmp_ge_u32 s68, 7
    s_cselect_b32 s70, 7, 0
    v_mfma_f32_16x16x32_bf16 v[184:187], v[112:115], a[108:111], v[184:187]
    s_sub_u32 s5, s68, s70
    s_mov_b32 s4, 0
    v_mfma_f32_16x16x32_bf16 v[188:191], v[116:119], a[96:99], v[188:191]
    s_mov_b32 s5, 0
    s_lshl_b32 s68, s41, 2
    v_mfma_f32_16x16x32_bf16 v[192:195], v[116:119], a[100:103], v[192:195]
    buffer_load_dwordx4 v20, s[56:59], s79 offen offset:2048 lds
    s_add_u32 s68, s68, s3
    v_mfma_f32_16x16x32_bf16 v[196:199], v[116:119], a[104:107], v[196:199]
    s_lshl_b32 s68, s68, 3
    s_lshl_b32 s69, s40, 8
    v_mfma_f32_16x16x32_bf16 v[200:203], v[116:119], a[108:111], v[200:203]
    s_add_u32 s68, s68, s69
    s_add_u32 s7, s68, 13672448
    v_mfma_f32_16x16x32_bf16 v[204:207], v[120:123], a[96:99], v[204:207]
    s_add_u32 s6, s68, 13664256
    v_mfma_f32_16x16x32_bf16 v[208:211], v[120:123], a[100:103], v[208:211]
    buffer_load_dwordx4 v21, s[56:59], s79 offen offset:3072 lds
    s_add_u32 s76, s76, 1
    s_cmp_eq_u32 s76, 14
    s_cselect_b32 s76, 0, s76
    v_mfma_f32_16x16x32_bf16 v[212:215], v[120:123], a[104:107], v[212:215]
    v_mfma_f32_16x16x32_bf16 v[216:219], v[120:123], a[108:111], v[216:219]
    s_waitcnt lgkmcnt(0)
    v_mfma_f32_16x16x32_bf16 v[156:159], v[92:95], a[112:115], v[156:159]
    s_add_u32 m0, s78, 12288
    s_mul_i32 s79, s76, 114688
    v_mfma_f32_16x16x32_bf16 v[160:163], v[92:95], a[116:119], v[160:163]
    buffer_load_dwordx4 v18, s[56:59], s79 offen lds
    s_waitcnt vmcnt(9)
    v_mfma_f32_16x16x32_bf16 v[164:167], v[92:95], a[120:123], v[164:167]
    ds_read_b64_tr_b16 v[108:109], v24 offset:0
    ds_read_b64_tr_b16 v[110:111], v24 offset:512
    v_mfma_f32_16x16x32_bf16 v[168:171], v[92:95], a[124:127], v[168:171]
    ds_read_b64_tr_b16 v[112:113], v25 offset:0
    ds_read_b64_tr_b16 v[114:115], v25 offset:512
    v_mfma_f32_16x16x32_bf16 v[172:175], v[96:99], a[112:115], v[172:175]
    ds_read_b64_tr_b16 v[116:117], v26 offset:0
    ds_read_b64_tr_b16 v[118:119], v26 offset:512
    v_mfma_f32_16x16x32_bf16 v[176:179], v[96:99], a[116:119], v[176:179]
    buffer_load_dwordx4 v19, s[56:59], s79 offen offset:1024 lds
    ds_read_b64_tr_b16 v[120:121], v27 offset:0
    v_mfma_f32_16x16x32_bf16 v[180:183], v[96:99], a[120:123], v[180:183]
    ds_read_b64_tr_b16 v[122:123], v27 offset:512
    v_mfma_f32_16x16x32_bf16 v[184:187], v[96:99], a[124:127], v[184:187]
    v_mfma_f32_16x16x32_bf16 v[188:191], v[100:103], a[112:115], v[188:191]
    v_mfma_f32_16x16x32_bf16 v[192:195], v[100:103], a[116:119], v[192:195]
    buffer_load_dwordx4 v20, s[56:59], s79 offen offset:2048 lds
    v_mfma_f32_16x16x32_bf16 v[196:199], v[100:103], a[120:123], v[196:199]
    v_mfma_f32_16x16x32_bf16 v[200:203], v[100:103], a[124:127], v[200:203]
    v_mfma_f32_16x16x32_bf16 v[204:207], v[104:107], a[112:115], v[204:207]
    v_mfma_f32_16x16x32_bf16 v[208:211], v[104:107], a[116:119], v[208:211]
    buffer_load_dwordx4 v21, s[56:59], s79 offen offset:3072 lds
    s_add_u32 s76, s76, 1
    s_cmp_eq_u32 s76, 14
    s_cselect_b32 s76, 0, s76
    v_mfma_f32_16x16x32_bf16 v[212:215], v[104:107], a[120:123], v[212:215]
    v_mfma_f32_16x16x32_bf16 v[216:219], v[104:107], a[124:127], v[216:219]
    s_waitcnt lgkmcnt(0)
    v_mfma_f32_16x16x32_bf16 v[156:159], v[108:111], a[128:131], v[156:159]
    s_add_u32 m0, s78, 16384
    s_mul_i32 s79, s76, 114688
    v_mfma_f32_16x16x32_bf16 v[160:163], v[108:111], a[132:135], v[160:163]
    buffer_load_dwordx4 v18, s[56:59], s79 offen lds
    s_waitcnt vmcnt(9)
    v_mfma_f32_16x16x32_bf16 v[164:167], v[108:111], a[136:139], v[164:167]
    ds_read_b64_tr_b16 v[92:93], v24 offset:4096
    ds_read_b64_tr_b16 v[94:95], v24 offset:4608
    v_mfma_f32_16x16x32_bf16 v[168:171], v[108:111], a[140:143], v[168:171]
    ds_read_b64_tr_b16 v[96:97], v25 offset:4096
    ds_read_b64_tr_b16 v[98:99], v25 offset:4608
    v_mfma_f32_16x16x32_bf16 v[172:175], v[112:115], a[128:131], v[172:175]
    ds_read_b64_tr_b16 v[100:101], v26 offset:4096
    ds_read_b64_tr_b16 v[102:103], v26 offset:4608
    v_mfma_f32_16x16x32_bf16 v[176:179], v[112:115], a[132:135], v[176:179]
    buffer_load_dwordx4 v19, s[56:59], s79 offen offset:1024 lds
    ds_read_b64_tr_b16 v[104:105], v27 offset:4096
    v_mfma_f32_16x16x32_bf16 v[180:183], v[112:115], a[136:139], v[180:183]
    ds_read_b64_tr_b16 v[106:107], v27 offset:4608
    v_mfma_f32_16x16x32_bf16 v[184:187], v[112:115], a[140:143], v[184:187]
    v_mfma_f32_16x16x32_bf16 v[188:191], v[116:119], a[128:131], v[188:191]
    v_mfma_f32_16x16x32_bf16 v[192:195], v[116:119], a[132:135], v[192:195]
    buffer_load_dwordx4 v20, s[56:59], s79 offen offset:2048 lds
    v_mfma_f32_16x16x32_bf16 v[196:199], v[116:119], a[136:139], v[196:199]
    v_mfma_f32_16x16x32_bf16 v[200:203], v[116:119], a[140:143], v[200:203]
    v_mfma_f32_16x16x32_bf16 v[204:207], v[120:123], a[128:131], v[204:207]
    v_mfma_f32_16x16x32_bf16 v[208:211], v[120:123], a[132:135], v[208:211]
    buffer_load_dwordx4 v21, s[56:59], s79 offen offset:3072 lds
    s_add_u32 s76, s76, 1
    s_cmp_eq_u32 s76, 14
    s_cselect_b32 s76, 0, s76
    v_mfma_f32_16x16x32_bf16 v[212:215], v[120:123], a[136:139], v[212:215]
    v_mfma_f32_16x16x32_bf16 v[216:219], v[120:123], a[140:143], v[216:219]
    s_waitcnt lgkmcnt(0)
    v_mfma_f32_16x16x32_bf16 v[156:159], v[92:95], a[144:147], v[156:159]
    s_add_u32 m0, s78, 0
    s_mul_i32 s79, s76, 114688
    v_mfma_f32_16x16x32_bf16 v[160:163], v[92:95], a[148:151], v[160:163]
    buffer_load_dwordx4 v18, s[56:59], s79 offen lds
    s_waitcnt vmcnt(9)
    v_mfma_f32_16x16x32_bf16 v[164:167], v[92:95], a[152:155], v[164:167]
    ds_read_b64_tr_b16 v[108:109], v24 offset:8192
    ds_read_b64_tr_b16 v[110:111], v24 offset:8704
    v_mfma_f32_16x16x32_bf16 v[168:171], v[92:95], a[156:159], v[168:171]
    ds_read_b64_tr_b16 v[112:113], v25 offset:8192
    ds_read_b64_tr_b16 v[114:115], v25 offset:8704
    v_mfma_f32_16x16x32_bf16 v[172:175], v[96:99], a[144:147], v[172:175]
    ds_read_b64_tr_b16 v[116:117], v26 offset:8192
    ds_read_b64_tr_b16 v[118:119], v26 offset:8704
    v_mfma_f32_16x16x32_bf16 v[176:179], v[96:99], a[148:151], v[176:179]
    buffer_load_dwordx4 v19, s[56:59], s79 offen offset:1024 lds
    ds_read_b64_tr_b16 v[120:121], v27 offset:8192
    v_mfma_f32_16x16x32_bf16 v[180:183], v[96:99], a[152:155], v[180:183]
    ds_read_b64_tr_b16 v[122:123], v27 offset:8704
    v_mfma_f32_16x16x32_bf16 v[184:187], v[96:99], a[156:159], v[184:187]
    v_mfma_f32_16x16x32_bf16 v[188:191], v[100:103], a[144:147], v[188:191]
    v_mfma_f32_16x16x32_bf16 v[192:195], v[100:103], a[148:151], v[192:195]
    buffer_load_dwordx4 v20, s[56:59], s79 offen offset:2048 lds
    v_mfma_f32_16x16x32_bf16 v[196:199], v[100:103], a[152:155], v[196:199]
    v_mfma_f32_16x16x32_bf16 v[200:203], v[100:103], a[156:159], v[200:203]
    v_mfma_f32_16x16x32_bf16 v[204:207], v[104:107], a[144:147], v[204:207]
    v_mfma_f32_16x16x32_bf16 v[208:211], v[104:107], a[148:151], v[208:211]
    buffer_load_dwordx4 v21, s[56:59], s79 offen offset:3072 lds
    s_add_u32 s76, s76, 1
    s_cmp_eq_u32 s76, 14
    s_cselect_b32 s76, 0, s76
    v_mfma_f32_16x16x32_bf16 v[212:215], v[104:107], a[152:155], v[212:215]
    v_mfma_f32_16x16x32_bf16 v[216:219], v[104:107], a[156:159], v[216:219]
    s_waitcnt lgkmcnt(0)
    v_mfma_f32_16x16x32_bf16 v[156:159], v[108:111], a[160:163], v[156:159]
    s_waitcnt vmcnt(8)
    ds_read_b64_tr_b16 v[92:93], v24 offset:12288
    v_mfma_f32_16x16x32_bf16 v[160:163], v[108:111], a[164:167], v[160:163]
    ds_read_b64_tr_b16 v[94:95], v24 offset:12800
    ds_read_b64_tr_b16 v[96:97], v25 offset:12288
    v_mfma_f32_16x16x32_bf16 v[164:167], v[108:111], a[168:171], v[164:167]
    ds_read_b64_tr_b16 v[98:99], v25 offset:12800
    ds_read_b64_tr_b16 v[100:101], v26 offset:12288
    v_mfma_f32_16x16x32_bf16 v[168:171], v[108:111], a[172:175], v[168:171]
    ds_read_b64_tr_b16 v[102:103], v26 offset:12800
    ds_read_b64_tr_b16 v[104:105], v27 offset:12288
    v_mfma_f32_16x16x32_bf16 v[172:175], v[112:115], a[160:163], v[172:175]
    ds_read_b64_tr_b16 v[106:107], v27 offset:12800
    buffer_load_dwordx4 v[124:127], v226, s[64:67], 0 offen sc1
    v_mfma_f32_16x16x32_bf16 v[176:179], v[112:115], a[164:167], v[176:179]
    buffer_load_dwordx4 v[128:131], v227, s[64:67], 0 offen sc1
    buffer_load_dwordx4 v[132:135], v228, s[64:67], 0 offen sc1
    v_mfma_f32_16x16x32_bf16 v[180:183], v[112:115], a[168:171], v[180:183]
    buffer_load_dwordx4 v[136:139], v229, s[64:67], 0 offen sc1
    buffer_load_dwordx4 v[140:143], v230, s[64:67], 0 offen sc1
    v_mfma_f32_16x16x32_bf16 v[184:187], v[112:115], a[172:175], v[184:187]
    buffer_load_dwordx4 v[144:147], v231, s[64:67], 0 offen sc1
    buffer_load_dwordx4 v[148:151], v232, s[64:67], 0 offen sc1
    v_mfma_f32_16x16x32_bf16 v[188:191], v[116:119], a[160:163], v[188:191]
    buffer_load_dwordx4 v[152:155], v233, s[64:67], 0 offen sc1
    v_min_u32 v10, 6, v0
    v_mfma_f32_16x16x32_bf16 v[192:195], v[116:119], a[164:167], v[192:195]
    v_lshlrev_b32 v10, 4, v10
    s_lshl_b32 s68, s40, 7
    v_mfma_f32_16x16x32_bf16 v[196:199], v[116:119], a[168:171], v[196:199]
    s_add_u32 s68, s68, 13684736
    buffer_load_dwordx4 v[240:243], v10, s[60:63], s68 offen sc1
    v_mfma_f32_16x16x32_bf16 v[200:203], v[116:119], a[172:175], v[200:203]
    v_mfma_f32_16x16x32_bf16 v[204:207], v[120:123], a[160:163], v[204:207]
    v_mfma_f32_16x16x32_bf16 v[208:211], v[120:123], a[164:167], v[208:211]
    v_mfma_f32_16x16x32_bf16 v[212:215], v[120:123], a[168:171], v[212:215]
    v_mfma_f32_16x16x32_bf16 v[216:219], v[120:123], a[172:175], v[216:219]
    s_waitcnt lgkmcnt(0)
    v_mfma_f32_16x16x32_bf16 v[156:159], v[92:95], a[176:179], v[156:159]
    s_waitcnt vmcnt(13)
    ds_read_b64_tr_b16 v[108:109], v24 offset:16384
    v_mfma_f32_16x16x32_bf16 v[160:163], v[92:95], a[180:183], v[160:163]
    ds_read_b64_tr_b16 v[110:111], v24 offset:16896
    ds_read_b64_tr_b16 v[112:113], v25 offset:16384
    v_mfma_f32_16x16x32_bf16 v[164:167], v[92:95], a[184:187], v[164:167]
    ds_read_b64_tr_b16 v[114:115], v25 offset:16896
    ds_read_b64_tr_b16 v[116:117], v26 offset:16384
    v_mfma_f32_16x16x32_bf16 v[168:171], v[92:95], a[188:191], v[168:171]
    ds_read_b64_tr_b16 v[118:119], v26 offset:16896
    ds_read_b64_tr_b16 v[120:121], v27 offset:16384
    v_mfma_f32_16x16x32_bf16 v[172:175], v[96:99], a[176:179], v[172:175]
    ds_read_b64_tr_b16 v[122:123], v27 offset:16896
    v_mfma_f32_16x16x32_bf16 v[176:179], v[96:99], a[180:183], v[176:179]
    v_mfma_f32_16x16x32_bf16 v[180:183], v[96:99], a[184:187], v[180:183]
    v_mfma_f32_16x16x32_bf16 v[184:187], v[96:99], a[188:191], v[184:187]
    v_mfma_f32_16x16x32_bf16 v[188:191], v[100:103], a[176:179], v[188:191]
    v_mfma_f32_16x16x32_bf16 v[192:195], v[100:103], a[180:183], v[192:195]
    v_mfma_f32_16x16x32_bf16 v[196:199], v[100:103], a[184:187], v[196:199]
    v_mfma_f32_16x16x32_bf16 v[200:203], v[100:103], a[188:191], v[200:203]
    v_mfma_f32_16x16x32_bf16 v[204:207], v[104:107], a[176:179], v[204:207]
    v_mfma_f32_16x16x32_bf16 v[208:211], v[104:107], a[180:183], v[208:211]
    v_mfma_f32_16x16x32_bf16 v[212:215], v[104:107], a[184:187], v[212:215]
    v_mfma_f32_16x16x32_bf16 v[216:219], v[104:107], a[188:191], v[216:219]
    s_waitcnt lgkmcnt(0)
    v_mfma_f32_16x16x32_bf16 v[156:159], v[108:111], a[192:195], v[156:159]
    s_waitcnt vmcnt(9)
    ds_read_b64_tr_b16 v[92:93], v24 offset:0
    v_mfma_f32_16x16x32_bf16 v[160:163], v[108:111], a[196:199], v[160:163]
    ds_read_b64_tr_b16 v[94:95], v24 offset:512
    ds_read_b64_tr_b16 v[96:97], v25 offset:0
    v_mfma_f32_16x16x32_bf16 v[164:167], v[108:111], a[200:203], v[164:167]
    ds_read_b64_tr_b16 v[98:99], v25 offset:512
    ds_read_b64_tr_b16 v[100:101], v26 offset:0
    v_mfma_f32_16x16x32_bf16 v[168:171], v[108:111], a[204:207], v[168:171]
    ds_read_b64_tr_b16 v[102:103], v26 offset:512
    ds_read_b64_tr_b16 v[104:105], v27 offset:0
    v_mfma_f32_16x16x32_bf16 v[172:175], v[112:115], a[192:195], v[172:175]
    ds_read_b64_tr_b16 v[106:107], v27 offset:512
    s_mov_b32 s68, 13680640
    v_mfma_f32_16x16x32_bf16 v[176:179], v[112:115], a[196:199], v[176:179]
    buffer_load_dwordx4 v[244:247], v12, s[60:63], s68 offen sc1
    v_mfma_f32_16x16x32_bf16 v[180:183], v[112:115], a[200:203], v[180:183]
    v_mfma_f32_16x16x32_bf16 v[184:187], v[112:115], a[204:207], v[184:187]
    v_mfma_f32_16x16x32_bf16 v[188:191], v[116:119], a[192:195], v[188:191]
    v_mfma_f32_16x16x32_bf16 v[192:195], v[116:119], a[196:199], v[192:195]
    v_mfma_f32_16x16x32_bf16 v[196:199], v[116:119], a[200:203], v[196:199]
    v_mfma_f32_16x16x32_bf16 v[200:203], v[116:119], a[204:207], v[200:203]
    v_mfma_f32_16x16x32_bf16 v[204:207], v[120:123], a[192:195], v[204:207]
    v_mfma_f32_16x16x32_bf16 v[208:211], v[120:123], a[196:199], v[208:211]
    v_mfma_f32_16x16x32_bf16 v[212:215], v[120:123], a[200:203], v[212:215]
    v_mfma_f32_16x16x32_bf16 v[216:219], v[120:123], a[204:207], v[216:219]
    s_waitcnt lgkmcnt(0)
    v_mfma_f32_16x16x32_bf16 v[156:159], v[92:95], a[208:211], v[156:159]
    v_mfma_f32_16x16x32_bf16 v[160:163], v[92:95], a[212:215], v[160:163]
    v_mfma_f32_16x16x32_bf16 v[164:167], v[92:95], a[216:219], v[164:167]
    v_mfma_f32_16x16x32_bf16 v[168:171], v[92:95], a[220:223], v[168:171]
    v_mfma_f32_16x16x32_bf16 v[172:175], v[96:99], a[208:211], v[172:175]
    v_mfma_f32_16x16x32_bf16 v[176:179], v[96:99], a[212:215], v[176:179]
    v_mfma_f32_16x16x32_bf16 v[180:183], v[96:99], a[216:219], v[180:183]
    v_mfma_f32_16x16x32_bf16 v[184:187], v[96:99], a[220:223], v[184:187]
    v_mfma_f32_16x16x32_bf16 v[188:191], v[100:103], a[208:211], v[188:191]
    v_mfma_f32_16x16x32_bf16 v[192:195], v[100:103], a[212:215], v[192:195]
    v_mfma_f32_16x16x32_bf16 v[196:199], v[100:103], a[216:219], v[196:199]
    v_mfma_f32_16x16x32_bf16 v[200:203], v[100:103], a[220:223], v[200:203]
    v_mfma_f32_16x16x32_bf16 v[204:207], v[104:107], a[208:211], v[204:207]
    v_mfma_f32_16x16x32_bf16 v[208:211], v[104:107], a[212:215], v[208:211]
    v_mfma_f32_16x16x32_bf16 v[212:215], v[104:107], a[216:219], v[212:215]
    v_mfma_f32_16x16x32_bf16 v[216:219], v[104:107], a[220:223], v[216:219]
    s_mov_b32 s68, 13680640
    s_waitcnt vmcnt(0)
    s_mov_b32 s82, 262144
POLL1:
    v_cmp_eq_u64 vcc, v[244:245], v[224:225]
    v_cmp_eq_u64 s[76:77], v[246:247], v[224:225]
    s_nop 0
    s_and_b64 vcc, vcc, s[76:77]
    s_cmp_eq_u64 vcc, exec
    s_cbranch_scc1 POLL1_OK
    s_sub_u32 s82, s82, 1
    s_cmp_eq_u32 s82, 0
    s_cbranch_scc1 POLL1_OK
    s_sleep 1
    buffer_load_dwordx4 v[244:247], v12, s[60:63], s68 offen sc1
    s_waitcnt vmcnt(0)
    s_branch POLL1
POLL1_OK:
    v_min_u32 v10, 6, v0
    v_lshlrev_b32 v10, 4, v10
    s_lshl_b32 s68, s40, 7
    s_add_u32 s68, s68, 13684736
    s_waitcnt vmcnt(1)
    s_mov_b32 s82, 262144
POLL2:
    v_cmp_eq_u64 vcc, v[240:241], v[224:225]
    s_nop 0
    s_cmp_eq_u64 vcc, exec
    s_cbranch_scc1 POLL2_OK
    s_sub_u32 s82, s82, 1
    s_cmp_eq_u32 s82, 0
    s_cbranch_scc1 POLL2_OK
    s_sleep 1
    buffer_load_dwordx4 v[240:243], v10, s[60:63], s68 offen sc1
    s_waitcnt vmcnt(0)
    s_branch POLL2
POLL2_OK:
    v_cmp_eq_u64 s[76:77], v[240:241], v[224:225]
    v_cmp_eq_u32 vcc, s9, v242
    s_nop 0
    s_and_b64 vcc, vcc, s[76:77]
    s_cmp_eq_u64 vcc, exec
    s_cselect_b32 s9, 1, 0
    s_waitcnt vmcnt(2)
    s_mov_b32 s82, 262144
KP_LBCHECK:
    v_mov_b32 v9, 0
    v_cmp_eq_u64 vcc, v[126:127], v[224:225]
    s_nop 1
    v_addc_co_u32 v9, vcc, 0, v9, vcc
    v_cmp_eq_u64 vcc, v[130:131], v[224:225]
    s_nop 1
    v_addc_co_u32 v9, vcc, 0, v9, vcc
    v_cmp_eq_u64 vcc, v[134:135], v[224:225]
    s_nop 1
    v_addc_co_u32 v9, vcc, 0, v9, vcc
    v_cmp_eq_u64 vcc, v[138:139], v[224:225]
    s_nop 1
    v_addc_co_u32 v9, vcc, 0, v9, vcc
    v_cmp_eq_u64 vcc, v[142:143], v[224:225]
    s_nop 1
    v_addc_co_u32 v9, vcc, 0, v9, vcc
    v_cmp_eq_u64 vcc, v[146:147], v[224:225]
    s_nop 1
    v_addc_co_u32 v9, vcc, 0, v9, vcc
    v_cmp_eq_u64 vcc, v[150:151], v[224:225]
    s_nop 1
    v_addc_co_u32 v9, vcc, 0, v9, vcc
    v_cmp_eq_u64 vcc, v[154:155], v[224:225]
    s_nop 1
    v_addc_co_u32 v9, vcc, 0, v9, vcc
    v_cmp_ne_u32 vcc, v9, v234
    s_cbranch_vccz KP_LBDONE
    s_sub_u32 s82, s82, 1
    s_cmp_eq_u32 s82, 0
    s_cbranch_scc1 KP_LBDONE
    s_sleep 1
    buffer_load_dwordx4 v[124:127], v226, s[64:67], 0 offen sc1
    buffer_load_dwordx4 v[128:131], v227, s[64:67], 0 offen sc1
    buffer_load_dwordx4 v[132:135], v228, s[64:67], 0 offen sc1
    buffer_load_dwordx4 v[136:139], v229, s[64:67], 0 offen sc1
    buffer_load_dwordx4 v[140:143], v230, s[64:67], 0 offen sc1
    buffer_load_dwordx4 v[144:147], v231, s[64:67], 0 offen sc1
    buffer_load_dwordx4 v[148:151], v232, s[64:67], 0 offen sc1
    buffer_load_dwordx4 v[152:155], v233, s[64:67], 0 offen sc1
    s_waitcnt vmcnt(0)
    s_branch KP_LBCHECK
KP_LBDONE:
    v_pk_fma_f32 v[244:245], v[152:153], v[56:57], v[148:149] op_sel:[0,0,0] op_sel_hi:[1,0,1]
    s_add_u32 s79, s43, 0
    buffer_load_dwordx4 a[0:3], v12, s[60:63], s79 offen offset:0 sc1
    v_pk_fma_f32 v[242:243], v[152:153], v[56:57], v[244:245] op_sel:[1,1,0] op_sel_hi:[0,1,1] neg_lo:[0,1,0]
    v_pk_fma_f32 v[244:245], v[242:243], v[56:57], v[144:145] op_sel:[0,0,0] op_sel_hi:[1,0,1]
    v_pk_fma_f32 v[242:243], v[242:243], v[56:57], v[244:245] op_sel:[1,1,0] op_sel_hi:[0,1,1] neg_lo:[0,1,0]
    v_pk_fma_f32 v[244:245], v[242:243], v[56:57], v[140:141] op_sel:[0,0,0] op_sel_hi:[1,0,1]
    v_pk_fma_f32 v[242:243], v[242:243], v[56:57], v[244:245] op_sel:[1,1,0] op_sel_hi:[0,1,1] neg_lo:[0,1,0]
    v_pk_fma_f32 v[244:245], v[242:243], v[56:57], v[136:137] op_sel:[0,0,0] op_sel_hi:[1,0,1]
    buffer_load_dwordx4 a[4:7], v12, s[60:63], s79 offen offset:1024 sc1
    v_pk_fma_f32 v[242:243], v[242:243], v[56:57], v[244:245] op_sel:[1,1,0] op_sel_hi:[0,1,1] neg_lo:[0,1,0]
    v_pk_fma_f32 v[244:245], v[242:243], v[56:57], v[132:133] op_sel:[0,0,0] op_sel_hi:[1,0,1]
    v_pk_fma_f32 v[242:243], v[242:243], v[56:57], v[244:245] op_sel:[1,1,0] op_sel_hi:[0,1,1] neg_lo:[0,1,0]
    v_pk_fma_f32 v[244:245], v[242:243], v[56:57], v[128:129] op_sel:[0,0,0] op_sel_hi:[1,0,1]
    v_pk_fma_f32 v[242:243], v[242:243], v[56:57], v[244:245] op_sel:[1,1,0] op_sel_hi:[0,1,1] neg_lo:[0,1,0]
    v_pk_fma_f32 v[244:245], v[242:243], v[56:57], v[124:125] op_sel:[0,0,0] op_sel_hi:[1,0,1]
    buffer_load_dwordx4 a[8:11], v12, s[60:63], s79 offen offset:2048 sc1
    v_pk_fma_f32 v[242:243], v[242:243], v[56:57], v[244:245] op_sel:[1,1,0] op_sel_hi:[0,1,1] neg_lo:[0,1,0]
    ds_write_b64 v14, v[242:243]
    s_waitcnt lgkmcnt(0)
    ds_read_b64 v[226:227], v15 offset:0
    ds_read_b64 v[228:229], v15 offset:128
    ds_read_b64 v[230:231], v15 offset:256
    buffer_load_dwordx4 a[12:15], v12, s[60:63], s79 offen offset:3072 sc1
    ds_read_b64 v[232:233], v15 offset:384
    s_waitcnt lgkmcnt(0)
    v_pk_fma_f32 v[244:245], v[232:233], v[54:55], v[230:231] op_sel:[0,0,0] op_sel_hi:[1,0,1]
    v_pk_fma_f32 v[242:243], v[232:233], v[54:55], v[244:245] op_sel:[1,1,0] op_sel_hi:[0,1,1] neg_lo:[0,1,0]
    v_pk_fma_f32 v[244:245], v[242:243], v[54:55], v[228:229] op_sel:[0,0,0] op_sel_hi:[1,0,1]
    v_pk_fma_f32 v[242:243], v[242:243], v[54:55], v[244:245] op_sel:[1,1,0] op_sel_hi:[0,1,1] neg_lo:[0,1,0]
    s_add_u32 s79, s43, 4096
    buffer_load_dwordx4 a[16:19], v12, s[60:63], s79 offen offset:0 sc1
    v_pk_fma_f32 v[244:245], v[242:243], v[54:55], v[226:227] op_sel:[0,0,0] op_sel_hi:[1,0,1]
    v_pk_fma_f32 v[242:243], v[242:243], v[54:55], v[244:245] op_sel:[1,1,0] op_sel_hi:[0,1,1] neg_lo:[0,1,0]
    v_pk_fma_f32 v[244:245], v[242:243], v[50:51], v[58:59] op_sel:[0,0,0] op_sel_hi:[1,0,1]
    v_pk_fma_f32 v[242:243], v[242:243], v[50:51], v[244:245] op_sel:[1,1,0] op_sel_hi:[0,1,1] neg_lo:[0,1,0]
    v_pk_fma_f32 v[244:245], v[242:243], v[44:45], v[60:61] op_sel:[0,0,0] op_sel_hi:[1,0,1]
    v_pk_fma_f32 v[60:61], v[242:243], v[44:45], v[244:245] op_sel:[1,1,0] op_sel_hi:[0,1,1] neg_lo:[0,1,0]
    buffer_load_dwordx4 a[20:23], v12, s[60:63], s79 offen offset:1024 sc1
    v_pk_fma_f32 v[244:245], v[60:61], v[44:45], v[62:63] op_sel:[0,0,0] op_sel_hi:[1,0,1]
    v_pk_fma_f32 v[62:63], v[60:61], v[44:45], v[244:245] op_sel:[1,1,0] op_sel_hi:[0,1,1] neg_lo:[0,1,0]
    v_pk_fma_f32 v[244:245], v[62:63], v[44:45], v[64:65] op_sel:[0,0,0] op_sel_hi:[1,0,1]
    v_pk_fma_f32 v[64:65], v[62:63], v[44:45], v[244:245] op_sel:[1,1,0] op_sel_hi:[0,1,1] neg_lo:[0,1,0]
    v_pk_fma_f32 v[244:245], v[64:65], v[44:45], v[66:67] op_sel:[0,0,0] op_sel_hi:[1,0,1]
    v_pk_fma_f32 v[66:67], v[64:65], v[44:45], v[244:245] op_sel:[1,1,0] op_sel_hi:[0,1,1] neg_lo:[0,1,0]
    buffer_load_dwordx4 a[24:27], v12, s[60:63], s79 offen offset:2048 sc1
    v_pk_fma_f32 v[244:245], v[66:67], v[44:45], v[68:69] op_sel:[0,0,0] op_sel_hi:[1,0,1]
    v_pk_fma_f32 v[68:69], v[66:67], v[44:45], v[244:245] op_sel:[1,1,0] op_sel_hi:[0,1,1] neg_lo:[0,1,0]
    v_pk_fma_f32 v[244:245], v[68:69], v[44:45], v[70:71] op_sel:[0,0,0] op_sel_hi:[1,0,1]
    v_pk_fma_f32 v[70:71], v[68:69], v[44:45], v[244:245] op_sel:[1,1,0] op_sel_hi:[0,1,1] neg_lo:[0,1,0]
    v_pk_fma_f32 v[244:245], v[70:71], v[44:45], v[72:73] op_sel:[0,0,0] op_sel_hi:[1,0,1]
    v_pk_fma_f32 v[72:73], v[70:71], v[44:45], v[244:245] op_sel:[1,1,0] op_sel_hi:[0,1,1] neg_lo:[0,1,0]
    buffer_load_dwordx4 a[28:31], v12, s[60:63], s79 offen offset:3072 sc1
    v_pk_fma_f32 v[244:245], v[72:73], v[44:45], v[74:75] op_sel:[0,0,0] op_sel_hi:[1,0,1]
    v_pk_fma_f32 v[74:75], v[72:73], v[44:45], v[244:245] op_sel:[1,1,0] op_sel_hi:[0,1,1] neg_lo:[0,1,0]
    v_pk_fma_f32 v[244:245], v[74:75], v[44:45], v[76:77] op_sel:[0,0,0] op_sel_hi:[1,0,1]
    v_pk_fma_f32 v[76:77], v[74:75], v[44:45], v[244:245] op_sel:[1,1,0] op_sel_hi:[0,1,1] neg_lo:[0,1,0]
    v_pk_fma_f32 v[244:245], v[76:77], v[44:45], v[78:79] op_sel:[0,0,0] op_sel_hi:[1,0,1]
    v_pk_fma_f32 v[78:79], v[76:77], v[44:45], v[244:245] op_sel:[1,1,0] op_sel_hi:[0,1,1] neg_lo:[0,1,0]
    s_add_u32 s79, s43, 8192
    buffer_load_dwordx4 a[32:35], v12, s[60:63], s79 offen offset:0 sc1
    v_pk_fma_f32 v[244:245], v[78:79], v[44:45], v[80:81] op_sel:[0,0,0] op_sel_hi:[1,0,1]
    v_pk_fma_f32 v[80:81], v[78:79], v[44:45], v[244:245] op_sel:[1,1,0] op_sel_hi:[0,1,1] neg_lo:[0,1,0]
    v_pk_fma_f32 v[244:245], v[80:81], v[44:45], v[82:83] op_sel:[0,0,0] op_sel_hi:[1,0,1]
    v_pk_fma_f32 v[82:83], v[80:81], v[44:45], v[244:245] op_sel:[1,1,0] op_sel_hi:[0,1,1] neg_lo:[0,1,0]
    v_pk_fma_f32 v[244:245], v[82:83], v[44:45], v[84:85] op_sel:[0,0,0] op_sel_hi:[1,0,1]
    v_pk_fma_f32 v[84:85], v[82:83], v[44:45], v[244:245] op_sel:[1,1,0] op_sel_hi:[0,1,1] neg_lo:[0,1,0]
    buffer_load_dwordx4 a[36:39], v12, s[60:63], s79 offen offset:1024 sc1
    v_pk_fma_f32 v[244:245], v[84:85], v[44:45], v[86:87] op_sel:[0,0,0] op_sel_hi:[1,0,1]
    v_pk_fma_f32 v[86:87], v[84:85], v[44:45], v[244:245] op_sel:[1,1,0] op_sel_hi:[0,1,1] neg_lo:[0,1,0]
    v_pk_fma_f32 v[244:245], v[86:87], v[44:45], v[88:89] op_sel:[0,0,0] op_sel_hi:[1,0,1]
    v_pk_fma_f32 v[88:89], v[86:87], v[44:45], v[244:245] op_sel:[1,1,0] op_sel_hi:[0,1,1] neg_lo:[0,1,0]
    v_pk_fma_f32 v[244:245], v[88:89], v[44:45], v[90:91] op_sel:[0,0,0] op_sel_hi:[1,0,1]
    v_pk_fma_f32 v[90:91], v[88:89], v[44:45], v[244:245] op_sel:[1,1,0] op_sel_hi:[0,1,1] neg_lo:[0,1,0]
    buffer_load_dwordx4 a[40:43], v12, s[60:63], s79 offen offset:2048 sc1
    s_lshl_b32 s68, s3, 12
    s_add_u32 s68, s68, 144128
    v_lshlrev_b32 v9, 10, v5
    v_lshl_add_u32 v9, v4, 2, v9
    v_add_u32_e64 v9, s68, v9
    v_cvt_pk_bf16_f32 v124, v60, -v61
    buffer_load_dwordx4 a[44:47], v12, s[60:63], s79 offen offset:3072 sc1
    ds_write_b32 v9, v124 offset:0
    v_cvt_pk_bf16_f32 v125, v62, -v63
    ds_write_b32 v9, v125 offset:64
    v_cvt_pk_bf16_f32 v126, v64, -v65
    ds_write_b32 v9, v126 offset:128
    v_cvt_pk_bf16_f32 v127, v66, -v67
    s_add_u32 s79, s43, 12288
    buffer_load_dwordx4 a[48:51], v12, s[60:63], s79 offen offset:0 sc1
    ds_write_b32 v9, v127 offset:192
    v_cvt_pk_bf16_f32 v128, v68, -v69
    ds_write_b32 v9, v128 offset:256
    v_cvt_pk_bf16_f32 v129, v70, -v71
    ds_write_b32 v9, v129 offset:320
    v_cvt_pk_bf16_f32 v130, v72, -v73
    buffer_load_dwordx4 a[52:55], v12, s[60:63], s79 offen offset:1024 sc1
    ds_write_b32 v9, v130 offset:384
    v_cvt_pk_bf16_f32 v131, v74, -v75
    ds_write_b32 v9, v131 offset:448
    v_cvt_pk_bf16_f32 v132, v76, -v77
    ds_write_b32 v9, v132 offset:512
    v_cvt_pk_bf16_f32 v133, v78, -v79
    buffer_load_dwordx4 a[56:59], v12, s[60:63], s79 offen offset:2048 sc1
    ds_write_b32 v9, v133 offset:576
    v_cvt_pk_bf16_f32 v134, v80, -v81
    ds_write_b32 v9, v134 offset:640
    v_cvt_pk_bf16_f32 v135, v82, -v83
    ds_write_b32 v9, v135 offset:704
    v_cvt_pk_bf16_f32 v136, v84, -v85
    buffer_load_dwordx4 a[60:63], v12, s[60:63], s79 offen offset:3072 sc1
    ds_write_b32 v9, v136 offset:768
    v_cvt_pk_bf16_f32 v137, v86, -v87
    ds_write_b32 v9, v137 offset:832
    v_cvt_pk_bf16_f32 v138, v88, -v89
    ds_write_b32 v9, v138 offset:896
    v_cvt_pk_bf16_f32 v139, v90, -v91
    ds_write_b32 v9, v139 offset:960
    v_lshrrev_b32 v10, 2, v4
    v_lshlrev_b32 v10, 4, v10
    v_and_b32 v11, 3, v4
    v_add_lshl_u32 v10, v10, v11, 6
    v_lshl_add_u32 v10, v5, 4, v10
    v_add_u32 v10, s68, v10
    s_waitcnt lgkmcnt(0)
    ds_read_b128 v[140:143], v10 offset:0
    ds_read_b128 v[144:147], v10 offset:256
    ds_read_b128 v[148:151], v10 offset:512
    ds_read_b128 v[152:155], v10 offset:768
    s_lshl_b32 s68, s41, 2
    s_add_u32 s68, s68, s3
    s_add_u32 s68, s68, 56
    s_lshl_b32 s68, s68, 12
    s_add_u32 s68, s81, s68
    s_cmp_eq_u32 s9, 1
    s_cbranch_scc1 KP_SST_F
    s_waitcnt lgkmcnt(3)
    buffer_store_dwordx4 v[140:143], v12, s[60:63], s68 offen offset:0 sc1
    s_waitcnt lgkmcnt(2)
    buffer_store_dwordx4 v[144:147], v12, s[60:63], s68 offen offset:1024 sc1
    s_waitcnt lgkmcnt(1)
    buffer_store_dwordx4 v[148:151], v12, s[60:63], s68 offen offset:2048 sc1
    s_waitcnt lgkmcnt(0)
    buffer_store_dwordx4 v[152:155], v12, s[60:63], s68 offen offset:3072 sc1
    s_branch KP_SST_E
KP_SST_F:
    s_waitcnt lgkmcnt(3)
    buffer_store_dwordx4 v[140:143], v12, s[60:63], s68 offen offset:0
    s_waitcnt lgkmcnt(2)
    buffer_store_dwordx4 v[144:147], v12, s[60:63], s68 offen offset:1024
    s_waitcnt lgkmcnt(1)
    buffer_store_dwordx4 v[148:151], v12, s[60:63], s68 offen offset:2048
    s_waitcnt lgkmcnt(0)
    buffer_store_dwordx4 v[152:155], v12, s[60:63], s68 offen offset:3072
KP_SST_E:
    s_cmp_eq_u32 s9, 1
    s_cbranch_scc1 KP_GELU_F
    s_waitcnt vmcnt(59)
    v_and_b32 v43, 0xffff0000, v35
    v_lshlrev_b32 v42, 16, v35
    v_and_b32 v41, 0xffff0000, v34
    v_lshlrev_b32 v40, 16, v34
    v_and_b32 v39, 0xffff0000, v33
    v_lshlrev_b32 v38, 16, v33
    v_and_b32 v37, 0xffff0000, v32
    v_lshlrev_b32 v36, 16, v32
    v_and_b32 v35, 0xffff0000, v31
    v_lshlrev_b32 v34, 16, v31
    v_and_b32 v33, 0xffff0000, v30
    v_lshlrev_b32 v32, 16, v30
    v_and_b32 v31, 0xffff0000, v29
    v_lshlrev_b32 v30, 16, v29
    v_and_b32 v29, 0xffff0000, v28
    v_lshlrev_b32 v28, 16, v28
    v_mov_b32 v250, 0xbdd2d3e8
    v_mov_b32 v251, 0xc0135761
    v_mov_b32 v252, 1.0
    s_lshl_b32 s68, s41, 3
    s_lshl_b32 s69, s3, 1
    s_add_u32 s68, s68, s69
    s_lshl_b32 s68, s68, 12
    s_add_u32 s68, s81, s68
    s_add_u32 s69, s68, 4096
    v_pk_fma_f32 v[156:157], v[156:157], v[220:221], v[28:29] op_sel:[0,0,0] op_sel_hi:[1,0,1]
    v_pk_fma_f32 v[158:159], v[158:159], v[220:221], v[30:31] op_sel:[0,0,0] op_sel_hi:[1,0,1]
    s_add_u32 s79, s43, 16384
    buffer_load_dwordx4 a[64:67], v12, s[60:63], s79 offen offset:0 sc1
    v_pk_mul_f32 v[244:245], v[156:157], v[156:157]
    v_pk_mul_f32 v[246:247], v[158:159], v[158:159]
    v_pk_fma_f32 v[244:245], v[244:245], v[250:251], v[250:251] op_sel:[0,0,1] op_sel_hi:[1,0,1]
    v_pk_fma_f32 v[246:247], v[246:247], v[250:251], v[250:251] op_sel:[0,0,1] op_sel_hi:[1,0,1]
    v_pk_mul_f32 v[244:245], v[244:245], v[156:157]
    v_pk_mul_f32 v[246:247], v[246:247], v[158:159]
    v_exp_f32 v244, v244
    v_exp_f32 v245, v245
    v_exp_f32 v246, v246
    v_exp_f32 v247, v247
    v_pk_add_f32 v[244:245], v[244:245], v[252:253] op_sel_hi:[1,0]
    v_pk_add_f32 v[246:247], v[246:247], v[252:253] op_sel_hi:[1,0]
    v_rcp_f32 v244, v244
    v_rcp_f32 v245, v245
    v_rcp_f32 v246, v246
    v_rcp_f32 v247, v247
    v_pk_mul_f32 v[156:157], v[156:157], v[244:245]
    v_pk_mul_f32 v[158:159], v[158:159], v[246:247]
    v_cvt_pk_bf16_f32 v236, v156, v157
    v_cvt_pk_bf16_f32 v237, v158, v159
    v_pk_fma_f32 v[172:173], v[172:173], v[220:221], v[32:33] op_sel:[0,0,0] op_sel_hi:[1,0,1]
    v_pk_fma_f32 v[174:175], v[174:175], v[220:221], v[34:35] op_sel:[0,0,0] op_sel_hi:[1,0,1]
    v_pk_mul_f32 v[244:245], v[172:173], v[172:173]
    v_pk_mul_f32 v[246:247], v[174:175], v[174:175]
    v_pk_fma_f32 v[244:245], v[244:245], v[250:251], v[250:251] op_sel:[0,0,1] op_sel_hi:[1,0,1]
    v_pk_fma_f32 v[246:247], v[246:247], v[250:251], v[250:251] op_sel:[0,0,1] op_sel_hi:[1,0,1]
    v_pk_mul_f32 v[244:245], v[244:245], v[172:173]
    v_pk_mul_f32 v[246:247], v[246:247], v[174:175]
    v_exp_f32 v244, v244
    buffer_load_dwordx4 a[68:71], v12, s[60:63], s79 offen offset:1024 sc1
    v_exp_f32 v245, v245
    v_exp_f32 v246, v246
    v_exp_f32 v247, v247
    v_pk_add_f32 v[244:245], v[244:245], v[252:253] op_sel_hi:[1,0]
    v_pk_add_f32 v[246:247], v[246:247], v[252:253] op_sel_hi:[1,0]
    v_rcp_f32 v244, v244
    v_rcp_f32 v245, v245
    v_rcp_f32 v246, v246
    v_rcp_f32 v247, v247
    v_pk_mul_f32 v[172:173], v[172:173], v[244:245]
    v_pk_mul_f32 v[174:175], v[174:175], v[246:247]
    v_cvt_pk_bf16_f32 v238, v172, v173
    v_cvt_pk_bf16_f32 v239, v174, v175
    buffer_store_dwordx4 v[236:239], v12, s[60:63], s68 offen offset:0 sc1
    v_pk_fma_f32 v[160:161], v[160:161], v[220:221], v[28:29] op_sel:[0,1,0] op_sel_hi:[1,1,1]
    v_pk_fma_f32 v[162:163], v[162:163], v[220:221], v[30:31] op_sel:[0,1,0] op_sel_hi:[1,1,1]
    v_pk_mul_f32 v[244:245], v[160:161], v[160:161]
    v_pk_mul_f32 v[246:247], v[162:163], v[162:163]
    v_pk_fma_f32 v[244:245], v[244:245], v[250:251], v[250:251] op_sel:[0,0,1] op_sel_hi:[1,0,1]
    v_pk_fma_f32 v[246:247], v[246:247], v[250:251], v[250:251] op_sel:[0,0,1] op_sel_hi:[1,0,1]
    v_pk_mul_f32 v[244:245], v[244:245], v[160:161]
    v_pk_mul_f32 v[246:247], v[246:247], v[162:163]
    v_exp_f32 v244, v244
    v_exp_f32 v245, v245
    v_exp_f32 v246, v246
    v_exp_f32 v247, v247
    v_pk_add_f32 v[244:245], v[244:245], v[252:253] op_sel_hi:[1,0]
    v_pk_add_f32 v[246:247], v[246:247], v[252:253] op_sel_hi:[1,0]
    v_rcp_f32 v244, v244
    buffer_load_dwordx4 a[72:75], v12, s[60:63], s79 offen offset:2048 sc1
    v_rcp_f32 v245, v245
    v_rcp_f32 v246, v246
    v_rcp_f32 v247, v247
    v_pk_mul_f32 v[160:161], v[160:161], v[244:245]
    v_pk_mul_f32 v[162:163], v[162:163], v[246:247]
    v_cvt_pk_bf16_f32 v240, v160, v161
    v_cvt_pk_bf16_f32 v241, v162, v163
    v_pk_fma_f32 v[176:177], v[176:177], v[220:221], v[32:33] op_sel:[0,1,0] op_sel_hi:[1,1,1]
    v_pk_fma_f32 v[178:179], v[178:179], v[220:221], v[34:35] op_sel:[0,1,0] op_sel_hi:[1,1,1]
    v_pk_mul_f32 v[244:245], v[176:177], v[176:177]
    v_pk_mul_f32 v[246:247], v[178:179], v[178:179]
    v_pk_fma_f32 v[244:245], v[244:245], v[250:251], v[250:251] op_sel:[0,0,1] op_sel_hi:[1,0,1]
    v_pk_fma_f32 v[246:247], v[246:247], v[250:251], v[250:251] op_sel:[0,0,1] op_sel_hi:[1,0,1]
    v_pk_mul_f32 v[244:245], v[244:245], v[176:177]
    v_pk_mul_f32 v[246:247], v[246:247], v[178:179]
    v_exp_f32 v244, v244
    v_exp_f32 v245, v245
    v_exp_f32 v246, v246
    v_exp_f32 v247, v247
    v_pk_add_f32 v[244:245], v[244:245], v[252:253] op_sel_hi:[1,0]
    v_pk_add_f32 v[246:247], v[246:247], v[252:253] op_sel_hi:[1,0]
    v_rcp_f32 v244, v244
    v_rcp_f32 v245, v245
    v_rcp_f32 v246, v246
    v_rcp_f32 v247, v247
    v_pk_mul_f32 v[176:177], v[176:177], v[244:245]
    v_pk_mul_f32 v[178:179], v[178:179], v[246:247]
    v_cvt_pk_bf16_f32 v242, v176, v177
    v_cvt_pk_bf16_f32 v243, v178, v179
    buffer_load_dwordx4 a[76:79], v12, s[60:63], s79 offen offset:3072 sc1
    buffer_store_dwordx4 v[240:243], v12, s[60:63], s68 offen offset:1024 sc1
    v_pk_fma_f32 v[164:165], v[164:165], v[222:223], v[28:29] op_sel:[0,0,0] op_sel_hi:[1,0,1]
    v_pk_fma_f32 v[166:167], v[166:167], v[222:223], v[30:31] op_sel:[0,0,0] op_sel_hi:[1,0,1]
    v_pk_mul_f32 v[244:245], v[164:165], v[164:165]
    v_pk_mul_f32 v[246:247], v[166:167], v[166:167]
    v_pk_fma_f32 v[244:245], v[244:245], v[250:251], v[250:251] op_sel:[0,0,1] op_sel_hi:[1,0,1]
    v_pk_fma_f32 v[246:247], v[246:247], v[250:251], v[250:251] op_sel:[0,0,1] op_sel_hi:[1,0,1]
    v_pk_mul_f32 v[244:245], v[244:245], v[164:165]
    v_pk_mul_f32 v[246:247], v[246:247], v[166:167]
    v_exp_f32 v244, v244
    v_exp_f32 v245, v245
    v_exp_f32 v246, v246
    v_exp_f32 v247, v247
    v_pk_add_f32 v[244:245], v[244:245], v[252:253] op_sel_hi:[1,0]
    v_pk_add_f32 v[246:247], v[246:247], v[252:253] op_sel_hi:[1,0]
    v_rcp_f32 v244, v244
    v_rcp_f32 v245, v245
    v_rcp_f32 v246, v246
    v_rcp_f32 v247, v247
    v_pk_mul_f32 v[164:165], v[164:165], v[244:245]
    v_pk_mul_f32 v[166:167], v[166:167], v[246:247]
    v_cvt_pk_bf16_f32 v236, v164, v165
    v_cvt_pk_bf16_f32 v237, v166, v167
    v_pk_fma_f32 v[180:181], v[180:181], v[222:223], v[32:33] op_sel:[0,0,0] op_sel_hi:[1,0,1]
    v_pk_fma_f32 v[182:183], v[182:183], v[222:223], v[34:35] op_sel:[0,0,0] op_sel_hi:[1,0,1]
    v_pk_mul_f32 v[244:245], v[180:181], v[180:181]
    v_pk_mul_f32 v[246:247], v[182:183], v[182:183]
    v_pk_fma_f32 v[244:245], v[244:245], v[250:251], v[250:251] op_sel:[0,0,1] op_sel_hi:[1,0,1]
    v_pk_fma_f32 v[246:247], v[246:247], v[250:251], v[250:251] op_sel:[0,0,1] op_sel_hi:[1,0,1]
    s_add_u32 s79, s43, 20480
    buffer_load_dwordx4 a[80:83], v12, s[60:63], s79 offen offset:0 sc1
    v_pk_mul_f32 v[244:245], v[244:245], v[180:181]
    v_pk_mul_f32 v[246:247], v[246:247], v[182:183]
    v_exp_f32 v244, v244
    v_exp_f32 v245, v245
    v_exp_f32 v246, v246
    v_exp_f32 v247, v247
    v_pk_add_f32 v[244:245], v[244:245], v[252:253] op_sel_hi:[1,0]
    v_pk_add_f32 v[246:247], v[246:247], v[252:253] op_sel_hi:[1,0]
    v_rcp_f32 v244, v244
    v_rcp_f32 v245, v245
    v_rcp_f32 v246, v246
    v_rcp_f32 v247, v247
    v_pk_mul_f32 v[180:181], v[180:181], v[244:245]
    v_pk_mul_f32 v[182:183], v[182:183], v[246:247]
    v_cvt_pk_bf16_f32 v238, v180, v181
    v_cvt_pk_bf16_f32 v239, v182, v183
    buffer_store_dwordx4 v[236:239], v12, s[60:63], s68 offen offset:2048 sc1
    v_pk_fma_f32 v[168:169], v[168:169], v[222:223], v[28:29] op_sel:[0,1,0] op_sel_hi:[1,1,1]
    v_pk_fma_f32 v[170:171], v[170:171], v[222:223], v[30:31] op_sel:[0,1,0] op_sel_hi:[1,1,1]
    v_pk_mul_f32 v[244:245], v[168:169], v[168:169]
    v_pk_mul_f32 v[246:247], v[170:171], v[170:171]
    v_pk_fma_f32 v[244:245], v[244:245], v[250:251], v[250:251] op_sel:[0,0,1] op_sel_hi:[1,0,1]
    v_pk_fma_f32 v[246:247], v[246:247], v[250:251], v[250:251] op_sel:[0,0,1] op_sel_hi:[1,0,1]
    v_pk_mul_f32 v[244:245], v[244:245], v[168:169]
    v_pk_mul_f32 v[246:247], v[246:247], v[170:171]
    v_exp_f32 v244, v244
    v_exp_f32 v245, v245
    v_exp_f32 v246, v246
    v_exp_f32 v247, v247
    buffer_load_dwordx4 a[84:87], v12, s[60:63], s79 offen offset:1024 sc1
    v_pk_add_f32 v[244:245], v[244:245], v[252:253] op_sel_hi:[1,0]
    v_pk_add_f32 v[246:247], v[246:247], v[252:253] op_sel_hi:[1,0]
    v_rcp_f32 v244, v244
    v_rcp_f32 v245, v245
    v_rcp_f32 v246, v246
    v_rcp_f32 v247, v247
    v_pk_mul_f32 v[168:169], v[168:169], v[244:245]
    v_pk_mul_f32 v[170:171], v[170:171], v[246:247]
    v_cvt_pk_bf16_f32 v240, v168, v169
    v_cvt_pk_bf16_f32 v241, v170, v171
    v_pk_fma_f32 v[184:185], v[184:185], v[222:223], v[32:33] op_sel:[0,1,0] op_sel_hi:[1,1,1]
    v_pk_fma_f32 v[186:187], v[186:187], v[222:223], v[34:35] op_sel:[0,1,0] op_sel_hi:[1,1,1]
    v_pk_mul_f32 v[244:245], v[184:185], v[184:185]
    v_pk_mul_f32 v[246:247], v[186:187], v[186:187]
    v_pk_fma_f32 v[244:245], v[244:245], v[250:251], v[250:251] op_sel:[0,0,1] op_sel_hi:[1,0,1]
    v_pk_fma_f32 v[246:247], v[246:247], v[250:251], v[250:251] op_sel:[0,0,1] op_sel_hi:[1,0,1]
    v_pk_mul_f32 v[244:245], v[244:245], v[184:185]
    v_pk_mul_f32 v[246:247], v[246:247], v[186:187]
    v_exp_f32 v244, v244
    v_exp_f32 v245, v245
    v_exp_f32 v246, v246
    v_exp_f32 v247, v247
    v_pk_add_f32 v[244:245], v[244:245], v[252:253] op_sel_hi:[1,0]
    v_pk_add_f32 v[246:247], v[246:247], v[252:253] op_sel_hi:[1,0]
    v_rcp_f32 v244, v244
    v_rcp_f32 v245, v245
    v_rcp_f32 v246, v246
    v_rcp_f32 v247, v247
    v_pk_mul_f32 v[184:185], v[184:185], v[244:245]
    buffer_load_dwordx4 a[88:91], v12, s[60:63], s79 offen offset:2048 sc1
    v_pk_mul_f32 v[186:187], v[186:187], v[246:247]
    v_cvt_pk_bf16_f32 v242, v184, v185
    v_cvt_pk_bf16_f32 v243, v186, v187
    buffer_store_dwordx4 v[240:243], v12, s[60:63], s68 offen offset:3072 sc1
    v_pk_fma_f32 v[188:189], v[188:189], v[220:221], v[36:37] op_sel:[0,0,0] op_sel_hi:[1,0,1]
    v_pk_fma_f32 v[190:191], v[190:191], v[220:221], v[38:39] op_sel:[0,0,0] op_sel_hi:[1,0,1]
    v_pk_mul_f32 v[244:245], v[188:189], v[188:189]
    v_pk_mul_f32 v[246:247], v[190:191], v[190:191]
    v_pk_fma_f32 v[244:245], v[244:245], v[250:251], v[250:251] op_sel:[0,0,1] op_sel_hi:[1,0,1]
    s_waitcnt vmcnt(11)
    v_mov_b32 v9, 0
    s_mov_b64 exec, 1
    buffer_store_dwordx2 v[224:225], v9, s[60:63], s7 offen sc1
    s_mov_b64 exec, -1
    v_pk_fma_f32 v[246:247], v[246:247], v[250:251], v[250:251] op_sel:[0,0,1] op_sel_hi:[1,0,1]
    v_pk_mul_f32 v[244:245], v[244:245], v[188:189]
    v_pk_mul_f32 v[246:247], v[246:247], v[190:191]
    v_exp_f32 v244, v244
    v_exp_f32 v245, v245
    v_exp_f32 v246, v246
    v_exp_f32 v247, v247
    v_pk_add_f32 v[244:245], v[244:245], v[252:253] op_sel_hi:[1,0]
    v_pk_add_f32 v[246:247], v[246:247], v[252:253] op_sel_hi:[1,0]
    v_rcp_f32 v244, v244
    v_rcp_f32 v245, v245
    v_rcp_f32 v246, v246
    v_rcp_f32 v247, v247
    v_pk_mul_f32 v[188:189], v[188:189], v[244:245]
    v_pk_mul_f32 v[190:191], v[190:191], v[246:247]
    v_cvt_pk_bf16_f32 v236, v188, v189
    v_cvt_pk_bf16_f32 v237, v190, v191
    v_pk_fma_f32 v[204:205], v[204:205], v[220:221], v[40:41] op_sel:[0,0,0] op_sel_hi:[1,0,1]
    v_pk_fma_f32 v[206:207], v[206:207], v[220:221], v[42:43] op_sel:[0,0,0] op_sel_hi:[1,0,1]
    v_pk_mul_f32 v[244:245], v[204:205], v[204:205]
    buffer_load_dwordx4 a[92:95], v12, s[60:63], s79 offen offset:3072 sc1
    v_pk_mul_f32 v[246:247], v[206:207], v[206:207]
    v_pk_fma_f32 v[244:245], v[244:245], v[250:251], v[250:251] op_sel:[0,0,1] op_sel_hi:[1,0,1]
    v_pk_fma_f32 v[246:247], v[246:247], v[250:251], v[250:251] op_sel:[0,0,1] op_sel_hi:[1,0,1]
    v_pk_mul_f32 v[244:245], v[244:245], v[204:205]
    v_pk_mul_f32 v[246:247], v[246:247], v[206:207]
    v_exp_f32 v244, v244
    v_exp_f32 v245, v245
    v_exp_f32 v246, v246
    v_exp_f32 v247, v247
    v_pk_add_f32 v[244:245], v[244:245], v[252:253] op_sel_hi:[1,0]
    v_pk_add_f32 v[246:247], v[246:247], v[252:253] op_sel_hi:[1,0]
    v_rcp_f32 v244, v244
    v_rcp_f32 v245, v245
    v_rcp_f32 v246, v246
    v_rcp_f32 v247, v247
    v_pk_mul_f32 v[204:205], v[204:205], v[244:245]
    v_pk_mul_f32 v[206:207], v[206:207], v[246:247]
    v_cvt_pk_bf16_f32 v238, v204, v205
    v_cvt_pk_bf16_f32 v239, v206, v207
    buffer_store_dwordx4 v[236:239], v12, s[60:63], s69 offen offset:0 sc1
    v_pk_fma_f32 v[192:193], v[192:193], v[220:221], v[36:37] op_sel:[0,1,0] op_sel_hi:[1,1,1]
    v_pk_fma_f32 v[194:195], v[194:195], v[220:221], v[38:39] op_sel:[0,1,0] op_sel_hi:[1,1,1]
    v_pk_mul_f32 v[244:245], v[192:193], v[192:193]
    v_pk_mul_f32 v[246:247], v[194:195], v[194:195]
    v_pk_fma_f32 v[244:245], v[244:245], v[250:251], v[250:251] op_sel:[0,0,1] op_sel_hi:[1,0,1]
    v_pk_fma_f32 v[246:247], v[246:247], v[250:251], v[250:251] op_sel:[0,0,1] op_sel_hi:[1,0,1]
    v_pk_mul_f32 v[244:245], v[244:245], v[192:193]
    v_pk_mul_f32 v[246:247], v[246:247], v[194:195]
    v_exp_f32 v244, v244
    s_add_u32 s79, s43, 24576
    buffer_load_dwordx4 a[96:99], v12, s[60:63], s79 offen offset:0 sc1
    v_exp_f32 v245, v245
    v_exp_f32 v246, v246
    v_exp_f32 v247, v247
    v_pk_add_f32 v[244:245], v[244:245], v[252:253] op_sel_hi:[1,0]
    v_pk_add_f32 v[246:247], v[246:247], v[252:253] op_sel_hi:[1,0]
    v_rcp_f32 v244, v244
    v_rcp_f32 v245, v245
    v_rcp_f32 v246, v246
    v_rcp_f32 v247, v247
    v_pk_mul_f32 v[192:193], v[192:193], v[244:245]
    v_pk_mul_f32 v[194:195], v[194:195], v[246:247]
    v_cvt_pk_bf16_f32 v240, v192, v193
    v_cvt_pk_bf16_f32 v241, v194, v195
    v_pk_fma_f32 v[208:209], v[208:209], v[220:221], v[40:41] op_sel:[0,1,0] op_sel_hi:[1,1,1]
    v_pk_fma_f32 v[210:211], v[210:211], v[220:221], v[42:43] op_sel:[0,1,0] op_sel_hi:[1,1,1]
    v_pk_mul_f32 v[244:245], v[208:209], v[208:209]
    v_pk_mul_f32 v[246:247], v[210:211], v[210:211]
    v_pk_fma_f32 v[244:245], v[244:245], v[250:251], v[250:251] op_sel:[0,0,1] op_sel_hi:[1,0,1]
    v_pk_fma_f32 v[246:247], v[246:247], v[250:251], v[250:251] op_sel:[0,0,1] op_sel_hi:[1,0,1]
    v_pk_mul_f32 v[244:245], v[244:245], v[208:209]
    v_pk_mul_f32 v[246:247], v[246:247], v[210:211]
    v_exp_f32 v244, v244
    v_exp_f32 v245, v245
    v_exp_f32 v246, v246
    v_exp_f32 v247, v247
    v_pk_add_f32 v[244:245], v[244:245], v[252:253] op_sel_hi:[1,0]
    v_pk_add_f32 v[246:247], v[246:247], v[252:253] op_sel_hi:[1,0]
    v_rcp_f32 v244, v244
    v_rcp_f32 v245, v245
    buffer_load_dwordx4 a[100:103], v12, s[60:63], s79 offen offset:1024 sc1
    v_rcp_f32 v246, v246
    v_rcp_f32 v247, v247
    v_pk_mul_f32 v[208:209], v[208:209], v[244:245]
    v_pk_mul_f32 v[210:211], v[210:211], v[246:247]
    v_cvt_pk_bf16_f32 v242, v208, v209
    v_cvt_pk_bf16_f32 v243, v210, v211
    buffer_store_dwordx4 v[240:243], v12, s[60:63], s69 offen offset:1024 sc1
    v_pk_fma_f32 v[196:197], v[196:197], v[222:223], v[36:37] op_sel:[0,0,0] op_sel_hi:[1,0,1]
    v_pk_fma_f32 v[198:199], v[198:199], v[222:223], v[38:39] op_sel:[0,0,0] op_sel_hi:[1,0,1]
    v_pk_mul_f32 v[244:245], v[196:197], v[196:197]
    v_pk_mul_f32 v[246:247], v[198:199], v[198:199]
    v_pk_fma_f32 v[244:245], v[244:245], v[250:251], v[250:251] op_sel:[0,0,1] op_sel_hi:[1,0,1]
    v_pk_fma_f32 v[246:247], v[246:247], v[250:251], v[250:251] op_sel:[0,0,1] op_sel_hi:[1,0,1]
    v_pk_mul_f32 v[244:245], v[244:245], v[196:197]
    v_pk_mul_f32 v[246:247], v[246:247], v[198:199]
    v_exp_f32 v244, v244
    v_exp_f32 v245, v245
    v_exp_f32 v246, v246
    v_exp_f32 v247, v247
    v_pk_add_f32 v[244:245], v[244:245], v[252:253] op_sel_hi:[1,0]
    v_pk_add_f32 v[246:247], v[246:247], v[252:253] op_sel_hi:[1,0]
    v_rcp_f32 v244, v244
    v_rcp_f32 v245, v245
    v_rcp_f32 v246, v246
    v_rcp_f32 v247, v247
    v_pk_mul_f32 v[196:197], v[196:197], v[244:245]
    v_pk_mul_f32 v[198:199], v[198:199], v[246:247]
    v_cvt_pk_bf16_f32 v236, v196, v197
    v_cvt_pk_bf16_f32 v237, v198, v199
    buffer_load_dwordx4 a[104:107], v12, s[60:63], s79 offen offset:2048 sc1
    v_pk_fma_f32 v[212:213], v[212:213], v[222:223], v[40:41] op_sel:[0,0,0] op_sel_hi:[1,0,1]
    v_pk_fma_f32 v[214:215], v[214:215], v[222:223], v[42:43] op_sel:[0,0,0] op_sel_hi:[1,0,1]
    v_pk_mul_f32 v[244:245], v[212:213], v[212:213]
    v_pk_mul_f32 v[246:247], v[214:215], v[214:215]
    v_pk_fma_f32 v[244:245], v[244:245], v[250:251], v[250:251] op_sel:[0,0,1] op_sel_hi:[1,0,1]
    v_pk_fma_f32 v[246:247], v[246:247], v[250:251], v[250:251] op_sel:[0,0,1] op_sel_hi:[1,0,1]
    v_pk_mul_f32 v[244:245], v[244:245], v[212:213]
    v_pk_mul_f32 v[246:247], v[246:247], v[214:215]
    v_exp_f32 v244, v244
    v_exp_f32 v245, v245
    v_exp_f32 v246, v246
    v_exp_f32 v247, v247
    v_pk_add_f32 v[244:245], v[244:245], v[252:253] op_sel_hi:[1,0]
    v_pk_add_f32 v[246:247], v[246:247], v[252:253] op_sel_hi:[1,0]
    v_rcp_f32 v244, v244
    v_rcp_f32 v245, v245
    v_rcp_f32 v246, v246
    v_rcp_f32 v247, v247
    v_pk_mul_f32 v[212:213], v[212:213], v[244:245]
    v_pk_mul_f32 v[214:215], v[214:215], v[246:247]
    v_cvt_pk_bf16_f32 v238, v212, v213
    v_cvt_pk_bf16_f32 v239, v214, v215
    buffer_store_dwordx4 v[236:239], v12, s[60:63], s69 offen offset:2048 sc1
    v_pk_fma_f32 v[200:201], v[200:201], v[222:223], v[36:37] op_sel:[0,1,0] op_sel_hi:[1,1,1]
    v_pk_fma_f32 v[202:203], v[202:203], v[222:223], v[38:39] op_sel:[0,1,0] op_sel_hi:[1,1,1]
    v_pk_mul_f32 v[244:245], v[200:201], v[200:201]
    v_pk_mul_f32 v[246:247], v[202:203], v[202:203]
    v_pk_fma_f32 v[244:245], v[244:245], v[250:251], v[250:251] op_sel:[0,0,1] op_sel_hi:[1,0,1]
    v_pk_fma_f32 v[246:247], v[246:247], v[250:251], v[250:251] op_sel:[0,0,1] op_sel_hi:[1,0,1]
    buffer_load_dwordx4 a[108:111], v12, s[60:63], s79 offen offset:3072 sc1
    v_pk_mul_f32 v[244:245], v[244:245], v[200:201]
    v_pk_mul_f32 v[246:247], v[246:247], v[202:203]
    v_exp_f32 v244, v244
    v_exp_f32 v245, v245
    v_exp_f32 v246, v246
    v_exp_f32 v247, v247
    v_pk_add_f32 v[244:245], v[244:245], v[252:253] op_sel_hi:[1,0]
    v_pk_add_f32 v[246:247], v[246:247], v[252:253] op_sel_hi:[1,0]
    v_rcp_f32 v244, v244
    v_rcp_f32 v245, v245
    v_rcp_f32 v246, v246
    v_rcp_f32 v247, v247
    v_pk_mul_f32 v[200:201], v[200:201], v[244:245]
    v_pk_mul_f32 v[202:203], v[202:203], v[246:247]
    v_cvt_pk_bf16_f32 v240, v200, v201
    v_cvt_pk_bf16_f32 v241, v202, v203
    v_pk_fma_f32 v[216:217], v[216:217], v[222:223], v[40:41] op_sel:[0,1,0] op_sel_hi:[1,1,1]
    v_pk_fma_f32 v[218:219], v[218:219], v[222:223], v[42:43] op_sel:[0,1,0] op_sel_hi:[1,1,1]
    v_pk_mul_f32 v[244:245], v[216:217], v[216:217]
    v_pk_mul_f32 v[246:247], v[218:219], v[218:219]
    v_pk_fma_f32 v[244:245], v[244:245], v[250:251], v[250:251] op_sel:[0,0,1] op_sel_hi:[1,0,1]
    v_pk_fma_f32 v[246:247], v[246:247], v[250:251], v[250:251] op_sel:[0,0,1] op_sel_hi:[1,0,1]
    v_pk_mul_f32 v[244:245], v[244:245], v[216:217]
    v_pk_mul_f32 v[246:247], v[246:247], v[218:219]
    v_exp_f32 v244, v244
    v_exp_f32 v245, v245
    v_exp_f32 v246, v246
    v_exp_f32 v247, v247
    v_pk_add_f32 v[244:245], v[244:245], v[252:253] op_sel_hi:[1,0]
    v_pk_add_f32 v[246:247], v[246:247], v[252:253] op_sel_hi:[1,0]
    v_rcp_f32 v244, v244
    v_rcp_f32 v245, v245
    v_rcp_f32 v246, v246
    v_rcp_f32 v247, v247
    v_pk_mul_f32 v[216:217], v[216:217], v[244:245]
    v_pk_mul_f32 v[218:219], v[218:219], v[246:247]
    v_cvt_pk_bf16_f32 v242, v216, v217
    v_cvt_pk_bf16_f32 v243, v218, v219
    buffer_store_dwordx4 v[240:243], v12, s[60:63], s69 offen offset:3072 sc1
    s_branch KP_GELU_E
KP_GELU_F:
    s_waitcnt vmcnt(59)
    v_and_b32 v43, 0xffff0000, v35
    v_lshlrev_b32 v42, 16, v35
    v_and_b32 v41, 0xffff0000, v34
    v_lshlrev_b32 v40, 16, v34
    v_and_b32 v39, 0xffff0000, v33
    v_lshlrev_b32 v38, 16, v33
    v_and_b32 v37, 0xffff0000, v32
    v_lshlrev_b32 v36, 16, v32
    v_and_b32 v35, 0xffff0000, v31
    v_lshlrev_b32 v34, 16, v31
    v_and_b32 v33, 0xffff0000, v30
    v_lshlrev_b32 v32, 16, v30
    v_and_b32 v31, 0xffff0000, v29
    v_lshlrev_b32 v30, 16, v29
    v_and_b32 v29, 0xffff0000, v28
    v_lshlrev_b32 v28, 16, v28
    v_mov_b32 v250, 0xbdd2d3e8
    v_mov_b32 v251, 0xc0135761
    v_mov_b32 v252, 1.0
    s_lshl_b32 s68, s41, 3
    s_lshl_b32 s69, s3, 1
    s_add_u32 s68, s68, s69
    s_lshl_b32 s68, s68, 12
    s_add_u32 s68, s81, s68
    s_add_u32 s69, s68, 4096
    v_pk_fma_f32 v[156:157], v[156:157], v[220:221], v[28:29] op_sel:[0,0,0] op_sel_hi:[1,0,1]
    v_pk_fma_f32 v[158:159], v[158:159], v[220:221], v[30:31] op_sel:[0,0,0] op_sel_hi:[1,0,1]
    s_add_u32 s79, s43, 16384
    buffer_load_dwordx4 a[64:67], v12, s[60:63], s79 offen offset:0 sc1
    v_pk_mul_f32 v[244:245], v[156:157], v[156:157]
    v_pk_mul_f32 v[246:247], v[158:159], v[158:159]
    v_pk_fma_f32 v[244:245], v[244:245], v[250:251], v[250:251] op_sel:[0,0,1] op_sel_hi:[1,0,1]
    v_pk_fma_f32 v[246:247], v[246:247], v[250:251], v[250:251] op_sel:[0,0,1] op_sel_hi:[1,0,1]
    v_pk_mul_f32 v[244:245], v[244:245], v[156:157]
    v_pk_mul_f32 v[246:247], v[246:247], v[158:159]
    v_exp_f32 v244, v244
    v_exp_f32 v245, v245
    v_exp_f32 v246, v246
    v_exp_f32 v247, v247
    v_pk_add_f32 v[244:245], v[244:245], v[252:253] op_sel_hi:[1,0]
    v_pk_add_f32 v[246:247], v[246:247], v[252:253] op_sel_hi:[1,0]
    v_rcp_f32 v244, v244
    v_rcp_f32 v245, v245
    v_rcp_f32 v246, v246
    v_rcp_f32 v247, v247
    v_pk_mul_f32 v[156:157], v[156:157], v[244:245]
    v_pk_mul_f32 v[158:159], v[158:159], v[246:247]
    v_cvt_pk_bf16_f32 v236, v156, v157
    v_cvt_pk_bf16_f32 v237, v158, v159
    v_pk_fma_f32 v[172:173], v[172:173], v[220:221], v[32:33] op_sel:[0,0,0] op_sel_hi:[1,0,1]
    v_pk_fma_f32 v[174:175], v[174:175], v[220:221], v[34:35] op_sel:[0,0,0] op_sel_hi:[1,0,1]
    v_pk_mul_f32 v[244:245], v[172:173], v[172:173]
    v_pk_mul_f32 v[246:247], v[174:175], v[174:175]
    v_pk_fma_f32 v[244:245], v[244:245], v[250:251], v[250:251] op_sel:[0,0,1] op_sel_hi:[1,0,1]
    v_pk_fma_f32 v[246:247], v[246:247], v[250:251], v[250:251] op_sel:[0,0,1] op_sel_hi:[1,0,1]
    v_pk_mul_f32 v[244:245], v[244:245], v[172:173]
    v_pk_mul_f32 v[246:247], v[246:247], v[174:175]
    v_exp_f32 v244, v244
    buffer_load_dwordx4 a[68:71], v12, s[60:63], s79 offen offset:1024 sc1
    v_exp_f32 v245, v245
    v_exp_f32 v246, v246
    v_exp_f32 v247, v247
    v_pk_add_f32 v[244:245], v[244:245], v[252:253] op_sel_hi:[1,0]
    v_pk_add_f32 v[246:247], v[246:247], v[252:253] op_sel_hi:[1,0]
    v_rcp_f32 v244, v244
    v_rcp_f32 v245, v245
    v_rcp_f32 v246, v246
    v_rcp_f32 v247, v247
    v_pk_mul_f32 v[172:173], v[172:173], v[244:245]
    v_pk_mul_f32 v[174:175], v[174:175], v[246:247]
    v_cvt_pk_bf16_f32 v238, v172, v173
    v_cvt_pk_bf16_f32 v239, v174, v175
    buffer_store_dwordx4 v[236:239], v12, s[60:63], s68 offen offset:0
    v_pk_fma_f32 v[160:161], v[160:161], v[220:221], v[28:29] op_sel:[0,1,0] op_sel_hi:[1,1,1]
    v_pk_fma_f32 v[162:163], v[162:163], v[220:221], v[30:31] op_sel:[0,1,0] op_sel_hi:[1,1,1]
    v_pk_mul_f32 v[244:245], v[160:161], v[160:161]
    v_pk_mul_f32 v[246:247], v[162:163], v[162:163]
    v_pk_fma_f32 v[244:245], v[244:245], v[250:251], v[250:251] op_sel:[0,0,1] op_sel_hi:[1,0,1]
    v_pk_fma_f32 v[246:247], v[246:247], v[250:251], v[250:251] op_sel:[0,0,1] op_sel_hi:[1,0,1]
    v_pk_mul_f32 v[244:245], v[244:245], v[160:161]
    v_pk_mul_f32 v[246:247], v[246:247], v[162:163]
    v_exp_f32 v244, v244
    v_exp_f32 v245, v245
    v_exp_f32 v246, v246
    v_exp_f32 v247, v247
    v_pk_add_f32 v[244:245], v[244:245], v[252:253] op_sel_hi:[1,0]
    v_pk_add_f32 v[246:247], v[246:247], v[252:253] op_sel_hi:[1,0]
    v_rcp_f32 v244, v244
    buffer_load_dwordx4 a[72:75], v12, s[60:63], s79 offen offset:2048 sc1
    v_rcp_f32 v245, v245
    v_rcp_f32 v246, v246
    v_rcp_f32 v247, v247
    v_pk_mul_f32 v[160:161], v[160:161], v[244:245]
    v_pk_mul_f32 v[162:163], v[162:163], v[246:247]
    v_cvt_pk_bf16_f32 v240, v160, v161
    v_cvt_pk_bf16_f32 v241, v162, v163
    v_pk_fma_f32 v[176:177], v[176:177], v[220:221], v[32:33] op_sel:[0,1,0] op_sel_hi:[1,1,1]
    v_pk_fma_f32 v[178:179], v[178:179], v[220:221], v[34:35] op_sel:[0,1,0] op_sel_hi:[1,1,1]
    v_pk_mul_f32 v[244:245], v[176:177], v[176:177]
    v_pk_mul_f32 v[246:247], v[178:179], v[178:179]
    v_pk_fma_f32 v[244:245], v[244:245], v[250:251], v[250:251] op_sel:[0,0,1] op_sel_hi:[1,0,1]
    v_pk_fma_f32 v[246:247], v[246:247], v[250:251], v[250:251] op_sel:[0,0,1] op_sel_hi:[1,0,1]
    v_pk_mul_f32 v[244:245], v[244:245], v[176:177]
    v_pk_mul_f32 v[246:247], v[246:247], v[178:179]
    v_exp_f32 v244, v244
    v_exp_f32 v245, v245
    v_exp_f32 v246, v246
    v_exp_f32 v247, v247
    v_pk_add_f32 v[244:245], v[244:245], v[252:253] op_sel_hi:[1,0]
    v_pk_add_f32 v[246:247], v[246:247], v[252:253] op_sel_hi:[1,0]
    v_rcp_f32 v244, v244
    v_rcp_f32 v245, v245
    v_rcp_f32 v246, v246
    v_rcp_f32 v247, v247
    v_pk_mul_f32 v[176:177], v[176:177], v[244:245]
    v_pk_mul_f32 v[178:179], v[178:179], v[246:247]
    v_cvt_pk_bf16_f32 v242, v176, v177
    v_cvt_pk_bf16_f32 v243, v178, v179
    buffer_load_dwordx4 a[76:79], v12, s[60:63], s79 offen offset:3072 sc1
    buffer_store_dwordx4 v[240:243], v12, s[60:63], s68 offen offset:1024
    v_pk_fma_f32 v[164:165], v[164:165], v[222:223], v[28:29] op_sel:[0,0,0] op_sel_hi:[1,0,1]
    v_pk_fma_f32 v[166:167], v[166:167], v[222:223], v[30:31] op_sel:[0,0,0] op_sel_hi:[1,0,1]
    v_pk_mul_f32 v[244:245], v[164:165], v[164:165]
    v_pk_mul_f32 v[246:247], v[166:167], v[166:167]
    v_pk_fma_f32 v[244:245], v[244:245], v[250:251], v[250:251] op_sel:[0,0,1] op_sel_hi:[1,0,1]
    v_pk_fma_f32 v[246:247], v[246:247], v[250:251], v[250:251] op_sel:[0,0,1] op_sel_hi:[1,0,1]
    v_pk_mul_f32 v[244:245], v[244:245], v[164:165]
    v_pk_mul_f32 v[246:247], v[246:247], v[166:167]
    v_exp_f32 v244, v244
    v_exp_f32 v245, v245
    v_exp_f32 v246, v246
    v_exp_f32 v247, v247
    v_pk_add_f32 v[244:245], v[244:245], v[252:253] op_sel_hi:[1,0]
    v_pk_add_f32 v[246:247], v[246:247], v[252:253] op_sel_hi:[1,0]
    v_rcp_f32 v244, v244
    v_rcp_f32 v245, v245
    v_rcp_f32 v246, v246
    v_rcp_f32 v247, v247
    v_pk_mul_f32 v[164:165], v[164:165], v[244:245]
    v_pk_mul_f32 v[166:167], v[166:167], v[246:247]
    v_cvt_pk_bf16_f32 v236, v164, v165
    v_cvt_pk_bf16_f32 v237, v166, v167
    v_pk_fma_f32 v[180:181], v[180:181], v[222:223], v[32:33] op_sel:[0,0,0] op_sel_hi:[1,0,1]
    v_pk_fma_f32 v[182:183], v[182:183], v[222:223], v[34:35] op_sel:[0,0,0] op_sel_hi:[1,0,1]
    v_pk_mul_f32 v[244:245], v[180:181], v[180:181]
    v_pk_mul_f32 v[246:247], v[182:183], v[182:183]
    v_pk_fma_f32 v[244:245], v[244:245], v[250:251], v[250:251] op_sel:[0,0,1] op_sel_hi:[1,0,1]
    v_pk_fma_f32 v[246:247], v[246:247], v[250:251], v[250:251] op_sel:[0,0,1] op_sel_hi:[1,0,1]
    s_add_u32 s79, s43, 20480
    buffer_load_dwordx4 a[80:83], v12, s[60:63], s79 offen offset:0 sc1
    v_pk_mul_f32 v[244:245], v[244:245], v[180:181]
    v_pk_mul_f32 v[246:247], v[246:247], v[182:183]
    v_exp_f32 v244, v244
    v_exp_f32 v245, v245
    v_exp_f32 v246, v246
    v_exp_f32 v247, v247
    v_pk_add_f32 v[244:245], v[244:245], v[252:253] op_sel_hi:[1,0]
    v_pk_add_f32 v[246:247], v[246:247], v[252:253] op_sel_hi:[1,0]
    v_rcp_f32 v244, v244
    v_rcp_f32 v245, v245
    v_rcp_f32 v246, v246
    v_rcp_f32 v247, v247
    v_pk_mul_f32 v[180:181], v[180:181], v[244:245]
    v_pk_mul_f32 v[182:183], v[182:183], v[246:247]
    v_cvt_pk_bf16_f32 v238, v180, v181
    v_cvt_pk_bf16_f32 v239, v182, v183
    buffer_store_dwordx4 v[236:239], v12, s[60:63], s68 offen offset:2048
    v_pk_fma_f32 v[168:169], v[168:169], v[222:223], v[28:29] op_sel:[0,1,0] op_sel_hi:[1,1,1]
    v_pk_fma_f32 v[170:171], v[170:171], v[222:223], v[30:31] op_sel:[0,1,0] op_sel_hi:[1,1,1]
    v_pk_mul_f32 v[244:245], v[168:169], v[168:169]
    v_pk_mul_f32 v[246:247], v[170:171], v[170:171]
    v_pk_fma_f32 v[244:245], v[244:245], v[250:251], v[250:251] op_sel:[0,0,1] op_sel_hi:[1,0,1]
    v_pk_fma_f32 v[246:247], v[246:247], v[250:251], v[250:251] op_sel:[0,0,1] op_sel_hi:[1,0,1]
    v_pk_mul_f32 v[244:245], v[244:245], v[168:169]
    v_pk_mul_f32 v[246:247], v[246:247], v[170:171]
    v_exp_f32 v244, v244
    v_exp_f32 v245, v245
    v_exp_f32 v246, v246
    v_exp_f32 v247, v247
    buffer_load_dwordx4 a[84:87], v12, s[60:63], s79 offen offset:1024 sc1
    v_pk_add_f32 v[244:245], v[244:245], v[252:253] op_sel_hi:[1,0]
    v_pk_add_f32 v[246:247], v[246:247], v[252:253] op_sel_hi:[1,0]
    v_rcp_f32 v244, v244
    v_rcp_f32 v245, v245
    v_rcp_f32 v246, v246
    v_rcp_f32 v247, v247
    v_pk_mul_f32 v[168:169], v[168:169], v[244:245]
    v_pk_mul_f32 v[170:171], v[170:171], v[246:247]
    v_cvt_pk_bf16_f32 v240, v168, v169
    v_cvt_pk_bf16_f32 v241, v170, v171
    v_pk_fma_f32 v[184:185], v[184:185], v[222:223], v[32:33] op_sel:[0,1,0] op_sel_hi:[1,1,1]
    v_pk_fma_f32 v[186:187], v[186:187], v[222:223], v[34:35] op_sel:[0,1,0] op_sel_hi:[1,1,1]
    v_pk_mul_f32 v[244:245], v[184:185], v[184:185]
    v_pk_mul_f32 v[246:247], v[186:187], v[186:187]
    v_pk_fma_f32 v[244:245], v[244:245], v[250:251], v[250:251] op_sel:[0,0,1] op_sel_hi:[1,0,1]
    v_pk_fma_f32 v[246:247], v[246:247], v[250:251], v[250:251] op_sel:[0,0,1] op_sel_hi:[1,0,1]
    v_pk_mul_f32 v[244:245], v[244:245], v[184:185]
    v_pk_mul_f32 v[246:247], v[246:247], v[186:187]
    v_exp_f32 v244, v244
    v_exp_f32 v245, v245
    v_exp_f32 v246, v246
    v_exp_f32 v247, v247
    v_pk_add_f32 v[244:245], v[244:245], v[252:253] op_sel_hi:[1,0]
    v_pk_add_f32 v[246:247], v[246:247], v[252:253] op_sel_hi:[1,0]
    v_rcp_f32 v244, v244
    v_rcp_f32 v245, v245
    v_rcp_f32 v246, v246
    v_rcp_f32 v247, v247
    v_pk_mul_f32 v[184:185], v[184:185], v[244:245]
    buffer_load_dwordx4 a[88:91], v12, s[60:63], s79 offen offset:2048 sc1
    v_pk_mul_f32 v[186:187], v[186:187], v[246:247]
    v_cvt_pk_bf16_f32 v242, v184, v185
    v_cvt_pk_bf16_f32 v243, v186, v187
    buffer_store_dwordx4 v[240:243], v12, s[60:63], s68 offen offset:3072
    v_pk_fma_f32 v[188:189], v[188:189], v[220:221], v[36:37] op_sel:[0,0,0] op_sel_hi:[1,0,1]
    v_pk_fma_f32 v[190:191], v[190:191], v[220:221], v[38:39] op_sel:[0,0,0] op_sel_hi:[1,0,1]
    v_pk_mul_f32 v[244:245], v[188:189], v[188:189]
    v_pk_mul_f32 v[246:247], v[190:191], v[190:191]
    v_pk_fma_f32 v[244:245], v[244:245], v[250:251], v[250:251] op_sel:[0,0,1] op_sel_hi:[1,0,1]
    s_waitcnt vmcnt(11)
    v_mov_b32 v9, 0
    s_mov_b64 exec, 1
    buffer_store_dwordx2 v[224:225], v9, s[60:63], s7 offen
    s_mov_b64 exec, -1
    v_pk_fma_f32 v[246:247], v[246:247], v[250:251], v[250:251] op_sel:[0,0,1] op_sel_hi:[1,0,1]
    v_pk_mul_f32 v[244:245], v[244:245], v[188:189]
    v_pk_mul_f32 v[246:247], v[246:247], v[190:191]
    v_exp_f32 v244, v244
    v_exp_f32 v245, v245
    v_exp_f32 v246, v246
    v_exp_f32 v247, v247
    v_pk_add_f32 v[244:245], v[244:245], v[252:253] op_sel_hi:[1,0]
    v_pk_add_f32 v[246:247], v[246:247], v[252:253] op_sel_hi:[1,0]
    v_rcp_f32 v244, v244
    v_rcp_f32 v245, v245
    v_rcp_f32 v246, v246
    v_rcp_f32 v247, v247
    v_pk_mul_f32 v[188:189], v[188:189], v[244:245]
    v_pk_mul_f32 v[190:191], v[190:191], v[246:247]
    v_cvt_pk_bf16_f32 v236, v188, v189
    v_cvt_pk_bf16_f32 v237, v190, v191
    v_pk_fma_f32 v[204:205], v[204:205], v[220:221], v[40:41] op_sel:[0,0,0] op_sel_hi:[1,0,1]
    v_pk_fma_f32 v[206:207], v[206:207], v[220:221], v[42:43] op_sel:[0,0,0] op_sel_hi:[1,0,1]
    v_pk_mul_f32 v[244:245], v[204:205], v[204:205]
    buffer_load_dwordx4 a[92:95], v12, s[60:63], s79 offen offset:3072 sc1
    v_pk_mul_f32 v[246:247], v[206:207], v[206:207]
    v_pk_fma_f32 v[244:245], v[244:245], v[250:251], v[250:251] op_sel:[0,0,1] op_sel_hi:[1,0,1]
    v_pk_fma_f32 v[246:247], v[246:247], v[250:251], v[250:251] op_sel:[0,0,1] op_sel_hi:[1,0,1]
    v_pk_mul_f32 v[244:245], v[244:245], v[204:205]
    v_pk_mul_f32 v[246:247], v[246:247], v[206:207]
    v_exp_f32 v244, v244
    v_exp_f32 v245, v245
    v_exp_f32 v246, v246
    v_exp_f32 v247, v247
    v_pk_add_f32 v[244:245], v[244:245], v[252:253] op_sel_hi:[1,0]
    v_pk_add_f32 v[246:247], v[246:247], v[252:253] op_sel_hi:[1,0]
    v_rcp_f32 v244, v244
    v_rcp_f32 v245, v245
    v_rcp_f32 v246, v246
    v_rcp_f32 v247, v247
    v_pk_mul_f32 v[204:205], v[204:205], v[244:245]
    v_pk_mul_f32 v[206:207], v[206:207], v[246:247]
    v_cvt_pk_bf16_f32 v238, v204, v205
    v_cvt_pk_bf16_f32 v239, v206, v207
    buffer_store_dwordx4 v[236:239], v12, s[60:63], s69 offen offset:0
    v_pk_fma_f32 v[192:193], v[192:193], v[220:221], v[36:37] op_sel:[0,1,0] op_sel_hi:[1,1,1]
    v_pk_fma_f32 v[194:195], v[194:195], v[220:221], v[38:39] op_sel:[0,1,0] op_sel_hi:[1,1,1]
    v_pk_mul_f32 v[244:245], v[192:193], v[192:193]
    v_pk_mul_f32 v[246:247], v[194:195], v[194:195]
    v_pk_fma_f32 v[244:245], v[244:245], v[250:251], v[250:251] op_sel:[0,0,1] op_sel_hi:[1,0,1]
    v_pk_fma_f32 v[246:247], v[246:247], v[250:251], v[250:251] op_sel:[0,0,1] op_sel_hi:[1,0,1]
    v_pk_mul_f32 v[244:245], v[244:245], v[192:193]
    v_pk_mul_f32 v[246:247], v[246:247], v[194:195]
    v_exp_f32 v244, v244
    s_add_u32 s79, s43, 24576
    buffer_load_dwordx4 a[96:99], v12, s[60:63], s79 offen offset:0 sc1
    v_exp_f32 v245, v245
    v_exp_f32 v246, v246
    v_exp_f32 v247, v247
    v_pk_add_f32 v[244:245], v[244:245], v[252:253] op_sel_hi:[1,0]
    v_pk_add_f32 v[246:247], v[246:247], v[252:253] op_sel_hi:[1,0]
    v_rcp_f32 v244, v244
    v_rcp_f32 v245, v245
    v_rcp_f32 v246, v246
    v_rcp_f32 v247, v247
    v_pk_mul_f32 v[192:193], v[192:193], v[244:245]
    v_pk_mul_f32 v[194:195], v[194:195], v[246:247]
    v_cvt_pk_bf16_f32 v240, v192, v193
    v_cvt_pk_bf16_f32 v241, v194, v195
    v_pk_fma_f32 v[208:209], v[208:209], v[220:221], v[40:41] op_sel:[0,1,0] op_sel_hi:[1,1,1]
    v_pk_fma_f32 v[210:211], v[210:211], v[220:221], v[42:43] op_sel:[0,1,0] op_sel_hi:[1,1,1]
    v_pk_mul_f32 v[244:245], v[208:209], v[208:209]
    v_pk_mul_f32 v[246:247], v[210:211], v[210:211]
    v_pk_fma_f32 v[244:245], v[244:245], v[250:251], v[250:251] op_sel:[0,0,1] op_sel_hi:[1,0,1]
    v_pk_fma_f32 v[246:247], v[246:247], v[250:251], v[250:251] op_sel:[0,0,1] op_sel_hi:[1,0,1]
    v_pk_mul_f32 v[244:245], v[244:245], v[208:209]
    v_pk_mul_f32 v[246:247], v[246:247], v[210:211]
    v_exp_f32 v244, v244
    v_exp_f32 v245, v245
    v_exp_f32 v246, v246
    v_exp_f32 v247, v247
    v_pk_add_f32 v[244:245], v[244:245], v[252:253] op_sel_hi:[1,0]
    v_pk_add_f32 v[246:247], v[246:247], v[252:253] op_sel_hi:[1,0]
    v_rcp_f32 v244, v244
    v_rcp_f32 v245, v245
    buffer_load_dwordx4 a[100:103], v12, s[60:63], s79 offen offset:1024 sc1
    v_rcp_f32 v246, v246
    v_rcp_f32 v247, v247
    v_pk_mul_f32 v[208:209], v[208:209], v[244:245]
    v_pk_mul_f32 v[210:211], v[210:211], v[246:247]
    v_cvt_pk_bf16_f32 v242, v208, v209
    v_cvt_pk_bf16_f32 v243, v210, v211
    buffer_store_dwordx4 v[240:243], v12, s[60:63], s69 offen offset:1024
    v_pk_fma_f32 v[196:197], v[196:197], v[222:223], v[36:37] op_sel:[0,0,0] op_sel_hi:[1,0,1]
    v_pk_fma_f32 v[198:199], v[198:199], v[222:223], v[38:39] op_sel:[0,0,0] op_sel_hi:[1,0,1]
    v_pk_mul_f32 v[244:245], v[196:197], v[196:197]
    v_pk_mul_f32 v[246:247], v[198:199], v[198:199]
    v_pk_fma_f32 v[244:245], v[244:245], v[250:251], v[250:251] op_sel:[0,0,1] op_sel_hi:[1,0,1]
    v_pk_fma_f32 v[246:247], v[246:247], v[250:251], v[250:251] op_sel:[0,0,1] op_sel_hi:[1,0,1]
    v_pk_mul_f32 v[244:245], v[244:245], v[196:197]
    v_pk_mul_f32 v[246:247], v[246:247], v[198:199]
    v_exp_f32 v244, v244
    v_exp_f32 v245, v245
    v_exp_f32 v246, v246
    v_exp_f32 v247, v247
    v_pk_add_f32 v[244:245], v[244:245], v[252:253] op_sel_hi:[1,0]
    v_pk_add_f32 v[246:247], v[246:247], v[252:253] op_sel_hi:[1,0]
    v_rcp_f32 v244, v244
    v_rcp_f32 v245, v245
    v_rcp_f32 v246, v246
    v_rcp_f32 v247, v247
    v_pk_mul_f32 v[196:197], v[196:197], v[244:245]
    v_pk_mul_f32 v[198:199], v[198:199], v[246:247]
    v_cvt_pk_bf16_f32 v236, v196, v197
    v_cvt_pk_bf16_f32 v237, v198, v199
    buffer_load_dwordx4 a[104:107], v12, s[60:63], s79 offen offset:2048 sc1
    v_pk_fma_f32 v[212:213], v[212:213], v[222:223], v[40:41] op_sel:[0,0,0] op_sel_hi:[1,0,1]
    v_pk_fma_f32 v[214:215], v[214:215], v[222:223], v[42:43] op_sel:[0,0,0] op_sel_hi:[1,0,1]
    v_pk_mul_f32 v[244:245], v[212:213], v[212:213]
    v_pk_mul_f32 v[246:247], v[214:215], v[214:215]
    v_pk_fma_f32 v[244:245], v[244:245], v[250:251], v[250:251] op_sel:[0,0,1] op_sel_hi:[1,0,1]
    v_pk_fma_f32 v[246:247], v[246:247], v[250:251], v[250:251] op_sel:[0,0,1] op_sel_hi:[1,0,1]
    v_pk_mul_f32 v[244:245], v[244:245], v[212:213]
    v_pk_mul_f32 v[246:247], v[246:247], v[214:215]
    v_exp_f32 v244, v244
    v_exp_f32 v245, v245
    v_exp_f32 v246, v246
    v_exp_f32 v247, v247
    v_pk_add_f32 v[244:245], v[244:245], v[252:253] op_sel_hi:[1,0]
    v_pk_add_f32 v[246:247], v[246:247], v[252:253] op_sel_hi:[1,0]
    v_rcp_f32 v244, v244
    v_rcp_f32 v245, v245
    v_rcp_f32 v246, v246
    v_rcp_f32 v247, v247
    v_pk_mul_f32 v[212:213], v[212:213], v[244:245]
    v_pk_mul_f32 v[214:215], v[214:215], v[246:247]
    v_cvt_pk_bf16_f32 v238, v212, v213
    v_cvt_pk_bf16_f32 v239, v214, v215
    buffer_store_dwordx4 v[236:239], v12, s[60:63], s69 offen offset:2048
    v_pk_fma_f32 v[200:201], v[200:201], v[222:223], v[36:37] op_sel:[0,1,0] op_sel_hi:[1,1,1]
    v_pk_fma_f32 v[202:203], v[202:203], v[222:223], v[38:39] op_sel:[0,1,0] op_sel_hi:[1,1,1]
    v_pk_mul_f32 v[244:245], v[200:201], v[200:201]
    v_pk_mul_f32 v[246:247], v[202:203], v[202:203]
    v_pk_fma_f32 v[244:245], v[244:245], v[250:251], v[250:251] op_sel:[0,0,1] op_sel_hi:[1,0,1]
    v_pk_fma_f32 v[246:247], v[246:247], v[250:251], v[250:251] op_sel:[0,0,1] op_sel_hi:[1,0,1]
    buffer_load_dwordx4 a[108:111], v12, s[60:63], s79 offen offset:3072 sc1
    v_pk_mul_f32 v[244:245], v[244:245], v[200:201]
    v_pk_mul_f32 v[246:247], v[246:247], v[202:203]
    v_exp_f32 v244, v244
    v_exp_f32 v245, v245
    v_exp_f32 v246, v246
    v_exp_f32 v247, v247
    v_pk_add_f32 v[244:245], v[244:245], v[252:253] op_sel_hi:[1,0]
    v_pk_add_f32 v[246:247], v[246:247], v[252:253] op_sel_hi:[1,0]
    v_rcp_f32 v244, v244
    v_rcp_f32 v245, v245
    v_rcp_f32 v246, v246
    v_rcp_f32 v247, v247
    v_pk_mul_f32 v[200:201], v[200:201], v[244:245]
    v_pk_mul_f32 v[202:203], v[202:203], v[246:247]
    v_cvt_pk_bf16_f32 v240, v200, v201
    v_cvt_pk_bf16_f32 v241, v202, v203
    v_pk_fma_f32 v[216:217], v[216:217], v[222:223], v[40:41] op_sel:[0,1,0] op_sel_hi:[1,1,1]
    v_pk_fma_f32 v[218:219], v[218:219], v[222:223], v[42:43] op_sel:[0,1,0] op_sel_hi:[1,1,1]
    v_pk_mul_f32 v[244:245], v[216:217], v[216:217]
    v_pk_mul_f32 v[246:247], v[218:219], v[218:219]
    v_pk_fma_f32 v[244:245], v[244:245], v[250:251], v[250:251] op_sel:[0,0,1] op_sel_hi:[1,0,1]
    v_pk_fma_f32 v[246:247], v[246:247], v[250:251], v[250:251] op_sel:[0,0,1] op_sel_hi:[1,0,1]
    v_pk_mul_f32 v[244:245], v[244:245], v[216:217]
    v_pk_mul_f32 v[246:247], v[246:247], v[218:219]
    v_exp_f32 v244, v244
    v_exp_f32 v245, v245
    v_exp_f32 v246, v246
    v_exp_f32 v247, v247
    v_pk_add_f32 v[244:245], v[244:245], v[252:253] op_sel_hi:[1,0]
    v_pk_add_f32 v[246:247], v[246:247], v[252:253] op_sel_hi:[1,0]
    v_rcp_f32 v244, v244
    v_rcp_f32 v245, v245
    v_rcp_f32 v246, v246
    v_rcp_f32 v247, v247
    v_pk_mul_f32 v[216:217], v[216:217], v[244:245]
    v_pk_mul_f32 v[218:219], v[218:219], v[246:247]
    v_cvt_pk_bf16_f32 v242, v216, v217
    v_cvt_pk_bf16_f32 v243, v218, v219
    buffer_store_dwordx4 v[240:243], v12, s[60:63], s69 offen offset:3072
KP_GELU_E:
    s_add_u32 s68, s3, 1
    s_and_b32 s68, s68, 3
    s_mul_i32 s68, s68, 12288
    s_add_u32 s68, s68, 4864
    v_add_u32 v6, s68, v12
    s_add_u32 s68, s3, 2
    s_and_b32 s68, s68, 3
    s_mul_i32 s68, s68, 12288
    s_add_u32 s68, s68, 8960
    v_add_u32 v7, s68, v12
    s_add_u32 s68, s3, 3
    s_and_b32 s68, s68, 3
    s_mul_i32 s68, s68, 12288
    s_add_u32 s68, s68, 13056
    v_add_u32 v8, s68, v12
    s_mul_i32 s68, s3, 12288
    s_add_u32 s68, s68, 4864
    v_add_u32 v13, s68, v12
    v_lshrrev_b32 v9, 2, v4
    v_lshlrev_b32 v9, 4, v9
    v_and_b32 v10, 3, v4
    v_add_u32 v9, v9, v10
    s_lshl_b32 s68, s3, 2
    v_add_u32 v9, s68, v9
    s_lshl_b32 s68, s40, 6
    v_add_u32 v18, s68, v9
    s_lshl_b32 s68, s41, 6
    v_lshl_add_u32 v10, v5, 2, s68
    v_lshlrev_b32 v20, 1, v10
    s_movk_i32 s68, 896
    v_mad_u32_u24 v19, v18, s68, v20
    v_lshlrev_b32 v9, 2, v9
    ds_read_b32 v250, v9 offset:512
    ds_read_b32 v251, v9 offset:0
    buffer_load_dwordx2 v[226:227], v19, s[44:47], 0 offen offset:0
    buffer_load_dwordx2 v[228:229], v19, s[44:47], 0 offen offset:32
    buffer_load_dwordx2 v[230:231], v19, s[44:47], 0 offen offset:64
    buffer_load_dwordx2 v[232:233], v19, s[44:47], 0 offen offset:96
    global_load_dwordx2 v[242:243], v20, s[20:21] offset:0
    global_load_dwordx2 v[234:235], v20, s[30:31] offset:0
    global_load_dwordx2 v[244:245], v20, s[20:21] offset:32
    global_load_dwordx2 v[236:237], v20, s[30:31] offset:32
    global_load_dwordx2 v[246:247], v20, s[20:21] offset:64
    global_load_dwordx2 v[238:239], v20, s[30:31] offset:64
    global_load_dwordx2 v[248:249], v20, s[20:21] offset:96
    global_load_dwordx2 v[240:241], v20, s[30:31] offset:96
    s_add_u32 s79, s39, 0
    buffer_load_dwordx4 a[112:115], v12, s[60:63], s79 offen offset:0 sc1
    buffer_load_dwordx4 a[116:119], v12, s[60:63], s79 offen offset:1024 sc1
    buffer_load_dwordx4 a[120:123], v12, s[60:63], s79 offen offset:2048 sc1
    buffer_load_dwordx4 a[124:127], v12, s[60:63], s79 offen offset:3072 sc1
    s_add_u32 s79, s39, 4096
    buffer_load_dwordx4 a[128:131], v12, s[60:63], s79 offen offset:0 sc1
    buffer_load_dwordx4 a[132:135], v12, s[60:63], s79 offen offset:1024 sc1
    buffer_load_dwordx4 a[136:139], v12, s[60:63], s79 offen offset:2048 sc1
    buffer_load_dwordx4 a[140:143], v12, s[60:63], s79 offen offset:3072 sc1
    s_waitcnt vmcnt(20)
    s_cmp_eq_u32 s9, 1
    s_cbranch_scc1 KP_HFL_F
    v_mov_b32 v9, 0
    s_mov_b64 exec, 1
    buffer_store_dwordx2 v[224:225], v9, s[60:63], s6 offen sc1
    s_mov_b64 exec, -1
    s_branch KP_HFL_E
KP_HFL_F:
    v_mov_b32 v9, 0
    s_mov_b64 exec, 1
    buffer_store_dwordx2 v[224:225], v9, s[60:63], s6 offen
    s_mov_b64 exec, -1
KP_HFL_E:
    s_lshl_b32 s69, s40, 8
    s_add_u32 s69, s69, 13672448
    s_add_u32 s79, s39, 8192
    buffer_load_dwordx4 a[144:147], v12, s[60:63], s79 offen offset:0 sc1
    buffer_load_dwordx4 a[148:151], v12, s[60:63], s79 offen offset:1024 sc1
    buffer_load_dwordx4 a[152:155], v12, s[60:63], s79 offen offset:2048 sc1
    buffer_load_dwordx4 a[156:159], v12, s[60:63], s79 offen offset:3072 sc1
    s_add_u32 s79, s39, 12288
    buffer_load_dwordx4 a[160:163], v12, s[60:63], s79 offen offset:0 sc1
    buffer_load_dwordx4 a[164:167], v12, s[60:63], s79 offen offset:1024 sc1
    buffer_load_dwordx4 a[168:171], v12, s[60:63], s79 offen offset:2048 sc1
    buffer_load_dwordx4 a[172:175], v12, s[60:63], s79 offen offset:3072 sc1
    buffer_load_dwordx2 v[14:15], v1, s[60:63], s69 offen sc1
    s_add_u32 s79, s39, 16384
    buffer_load_dwordx4 a[176:179], v12, s[60:63], s79 offen offset:0 sc1
    buffer_load_dwordx4 a[180:183], v12, s[60:63], s79 offen offset:1024 sc1
    buffer_load_dwordx4 a[184:187], v12, s[60:63], s79 offen offset:2048 sc1
    buffer_load_dwordx4 a[188:191], v12, s[60:63], s79 offen offset:3072 sc1
    s_add_u32 s79, s39, 20480
    buffer_load_dwordx4 a[192:195], v12, s[60:63], s79 offen offset:0 sc1
    buffer_load_dwordx4 a[196:199], v12, s[60:63], s79 offen offset:1024 sc1
    buffer_load_dwordx4 a[200:203], v12, s[60:63], s79 offen offset:2048 sc1
    buffer_load_dwordx4 a[204:207], v12, s[60:63], s79 offen offset:3072 sc1
    s_waitcnt vmcnt(8)
    s_mov_b32 s82, 262144
POLL3:
    v_cmp_eq_u64 vcc, v[14:15], v[224:225]
    s_nop 0
    s_cmp_eq_u64 vcc, exec
    s_cbranch_scc1 POLL3_OK
    s_sub_u32 s82, s82, 1
    s_cmp_eq_u32 s82, 0
    s_cbranch_scc1 POLL3_OK
    s_sleep 1
    buffer_load_dwordx2 v[14:15], v1, s[60:63], s69 offen sc1
    s_waitcnt vmcnt(0)
    s_branch POLL3
POLL3_OK:
    s_add_u32 s71, s42, 0
    buffer_load_dwordx4 v[28:31], v16, s[60:63], s71 offen sc1
    buffer_load_dwordx4 v[32:35], v17, s[60:63], s71 offen sc1
    buffer_load_dwordx4 v[36:39], v22, s[60:63], s71 offen sc1
    buffer_load_dwordx4 v[40:43], v23, s[60:63], s71 offen sc1
    s_add_u32 s71, s42, 4096
    buffer_load_dwordx4 v[44:47], v16, s[60:63], s71 offen sc1
    buffer_load_dwordx4 v[48:51], v17, s[60:63], s71 offen sc1
    buffer_load_dwordx4 v[52:55], v22, s[60:63], s71 offen sc1
    buffer_load_dwordx4 v[56:59], v23, s[60:63], s71 offen sc1
    s_add_u32 s71, s42, 8192
    buffer_load_dwordx4 v[60:63], v16, s[60:63], s71 offen sc1
    buffer_load_dwordx4 v[64:67], v17, s[60:63], s71 offen sc1
    buffer_load_dwordx4 v[68:71], v22, s[60:63], s71 offen sc1
    buffer_load_dwordx4 v[72:75], v23, s[60:63], s71 offen sc1
    s_add_u32 s71, s42, 12288
    buffer_load_dwordx4 v[76:79], v16, s[60:63], s71 offen sc1
    buffer_load_dwordx4 v[80:83], v17, s[60:63], s71 offen sc1
    buffer_load_dwordx4 v[84:87], v22, s[60:63], s71 offen sc1
    buffer_load_dwordx4 v[88:91], v23, s[60:63], s71 offen sc1
    v_add_u32 v21, s78, v12
    s_waitcnt vmcnt(12)
    s_waitcnt vmcnt(63)
    v_mfma_f32_16x16x32_bf16 v[92:95], a[0:3], v[28:31], 0
    s_add_u32 s71, s42, 16384
    v_mfma_f32_16x16x32_bf16 v[108:111], a[4:7], v[28:31], 0
    s_add_u32 s79, s39, 24576
    buffer_load_dwordx4 a[208:211], v12, s[60:63], s79 offen offset:0 sc1
    v_mfma_f32_16x16x32_bf16 v[124:127], a[8:11], v[28:31], 0
    v_mfma_f32_16x16x32_bf16 v[140:143], a[12:15], v[28:31], 0
    buffer_load_dwordx4 v[28:31], v16, s[60:63], s71 offen sc1
    v_mfma_f32_16x16x32_bf16 v[96:99], a[0:3], v[32:35], 0
    v_mfma_f32_16x16x32_bf16 v[112:115], a[4:7], v[32:35], 0
    buffer_load_dwordx4 a[212:215], v12, s[60:63], s79 offen offset:1024 sc1
    v_mfma_f32_16x16x32_bf16 v[128:131], a[8:11], v[32:35], 0
    v_mfma_f32_16x16x32_bf16 v[144:147], a[12:15], v[32:35], 0
    buffer_load_dwordx4 v[32:35], v17, s[60:63], s71 offen sc1
    v_mfma_f32_16x16x32_bf16 v[100:103], a[0:3], v[36:39], 0
    v_mfma_f32_16x16x32_bf16 v[116:119], a[4:7], v[36:39], 0
    buffer_load_dwordx4 a[216:219], v12, s[60:63], s79 offen offset:2048 sc1
    v_mfma_f32_16x16x32_bf16 v[132:135], a[8:11], v[36:39], 0
    v_mfma_f32_16x16x32_bf16 v[148:151], a[12:15], v[36:39], 0
    buffer_load_dwordx4 v[36:39], v22, s[60:63], s71 offen sc1
    v_mfma_f32_16x16x32_bf16 v[104:107], a[0:3], v[40:43], 0
    v_mfma_f32_16x16x32_bf16 v[120:123], a[4:7], v[40:43], 0
    buffer_load_dwordx4 a[220:223], v12, s[60:63], s79 offen offset:3072 sc1
    v_mfma_f32_16x16x32_bf16 v[136:139], a[8:11], v[40:43], 0
    v_mfma_f32_16x16x32_bf16 v[152:155], a[12:15], v[40:43], 0
    buffer_load_dwordx4 v[40:43], v23, s[60:63], s71 offen sc1
    s_waitcnt vmcnt(16)
    s_waitcnt vmcnt(63)
    v_mfma_f32_16x16x32_bf16 v[92:95], a[16:19], v[44:47], v[92:95]
    s_add_u32 s71, s42, 20480
    v_mfma_f32_16x16x32_bf16 v[108:111], a[20:23], v[44:47], v[108:111]
    s_lshl_b32 s69, s40, 8
    s_add_u32 s79, s39, 28672
    buffer_load_dwordx4 a[224:227], v12, s[60:63], s79 offen offset:0 sc1
    v_mfma_f32_16x16x32_bf16 v[124:127], a[24:27], v[44:47], v[124:127]
    s_add_u32 s69, s69, 13664256
    v_mfma_f32_16x16x32_bf16 v[140:143], a[28:31], v[44:47], v[140:143]
    buffer_load_dwordx2 v[14:15], v1, s[60:63], s69 offen sc1
    buffer_load_dwordx4 v[44:47], v16, s[60:63], s71 offen sc1
    v_mfma_f32_16x16x32_bf16 v[96:99], a[16:19], v[48:51], v[96:99]
    v_mfma_f32_16x16x32_bf16 v[112:115], a[20:23], v[48:51], v[112:115]
    buffer_load_dwordx4 a[228:231], v12, s[60:63], s79 offen offset:1024 sc1
    v_mfma_f32_16x16x32_bf16 v[128:131], a[24:27], v[48:51], v[128:131]
    v_mfma_f32_16x16x32_bf16 v[144:147], a[28:31], v[48:51], v[144:147]
    buffer_load_dwordx4 v[48:51], v17, s[60:63], s71 offen sc1
    v_mfma_f32_16x16x32_bf16 v[100:103], a[16:19], v[52:55], v[100:103]
    v_mfma_f32_16x16x32_bf16 v[116:119], a[20:23], v[52:55], v[116:119]
    buffer_load_dwordx4 a[232:235], v12, s[60:63], s79 offen offset:2048 sc1
    v_mfma_f32_16x16x32_bf16 v[132:135], a[24:27], v[52:55], v[132:135]
    v_mfma_f32_16x16x32_bf16 v[148:151], a[28:31], v[52:55], v[148:151]
    buffer_load_dwordx4 v[52:55], v22, s[60:63], s71 offen sc1
    v_mfma_f32_16x16x32_bf16 v[104:107], a[16:19], v[56:59], v[104:107]
    v_mfma_f32_16x16x32_bf16 v[120:123], a[20:23], v[56:59], v[120:123]
    buffer_load_dwordx4 a[236:239], v12, s[60:63], s79 offen offset:3072 sc1
    v_mfma_f32_16x16x32_bf16 v[136:139], a[24:27], v[56:59], v[136:139]
    v_mfma_f32_16x16x32_bf16 v[152:155], a[28:31], v[56:59], v[152:155]
    buffer_load_dwordx4 v[56:59], v23, s[60:63], s71 offen sc1
    s_waitcnt vmcnt(21)
    s_waitcnt vmcnt(63)
    v_mfma_f32_16x16x32_bf16 v[92:95], a[32:35], v[60:63], v[92:95]
    s_add_u32 s71, s42, 24576
    v_mfma_f32_16x16x32_bf16 v[108:111], a[36:39], v[60:63], v[108:111]
    s_add_u32 s79, s39, 32768
    buffer_load_dwordx4 a[240:243], v12, s[60:63], s79 offen offset:0 sc1
    v_mfma_f32_16x16x32_bf16 v[124:127], a[40:43], v[60:63], v[124:127]
    v_mfma_f32_16x16x32_bf16 v[140:143], a[44:47], v[60:63], v[140:143]
    buffer_load_dwordx4 v[60:63], v16, s[60:63], s71 offen sc1
    v_mfma_f32_16x16x32_bf16 v[96:99], a[32:35], v[64:67], v[96:99]
    v_mfma_f32_16x16x32_bf16 v[112:115], a[36:39], v[64:67], v[112:115]
    buffer_load_dwordx4 a[244:247], v12, s[60:63], s79 offen offset:1024 sc1
    v_mfma_f32_16x16x32_bf16 v[128:131], a[40:43], v[64:67], v[128:131]
    v_mfma_f32_16x16x32_bf16 v[144:147], a[44:47], v[64:67], v[144:147]
    buffer_load_dwordx4 v[64:67], v17, s[60:63], s71 offen sc1
    v_mfma_f32_16x16x32_bf16 v[100:103], a[32:35], v[68:71], v[100:103]
    v_mfma_f32_16x16x32_bf16 v[116:119], a[36:39], v[68:71], v[116:119]
    buffer_load_dwordx4 a[248:251], v12, s[60:63], s79 offen offset:2048 sc1
    v_mfma_f32_16x16x32_bf16 v[132:135], a[40:43], v[68:71], v[132:135]
    v_mfma_f32_16x16x32_bf16 v[148:151], a[44:47], v[68:71], v[148:151]
    buffer_load_dwordx4 v[68:71], v22, s[60:63], s71 offen sc1
    v_mfma_f32_16x16x32_bf16 v[104:107], a[32:35], v[72:75], v[104:107]
    v_mfma_f32_16x16x32_bf16 v[120:123], a[36:39], v[72:75], v[120:123]
    buffer_load_dwordx4 a[252:255], v12, s[60:63], s79 offen offset:3072 sc1
    v_mfma_f32_16x16x32_bf16 v[136:139], a[40:43], v[72:75], v[136:139]
    v_mfma_f32_16x16x32_bf16 v[152:155], a[44:47], v[72:75], v[152:155]
    buffer_load_dwordx4 v[72:75], v23, s[60:63], s71 offen sc1
    s_waitcnt vmcnt(15)
    s_mov_b32 s82, 262144
POLL4:
    v_cmp_eq_u64 vcc, v[14:15], v[224:225]
    s_nop 0
    s_cmp_eq_u64 vcc, exec
    s_cbranch_scc1 POLL4_OK
    s_sub_u32 s82, s82, 1
    s_cmp_eq_u32 s82, 0
    s_cbranch_scc1 POLL4_OK
    s_sleep 1
    buffer_load_dwordx2 v[14:15], v1, s[60:63], s69 offen sc1
    s_waitcnt vmcnt(0)
    s_branch POLL4
POLL4_OK:
    s_waitcnt vmcnt(25)
    s_waitcnt vmcnt(63)
    v_mfma_f32_16x16x32_bf16 v[92:95], a[48:51], v[76:79], v[92:95]
    s_add_u32 s71, s38, 0
    v_mfma_f32_16x16x32_bf16 v[108:111], a[52:55], v[76:79], v[108:111]
    s_add_u32 m0, s78, 0
    s_add_u32 s79, s39, 36864
    buffer_load_dwordx4 v12, s[60:63], s79 offen offset:0 sc1 lds
    v_mfma_f32_16x16x32_bf16 v[124:127], a[56:59], v[76:79], v[124:127]
    v_mfma_f32_16x16x32_bf16 v[140:143], a[60:63], v[76:79], v[140:143]
    buffer_load_dwordx4 v[76:79], v16, s[60:63], s71 offen sc1
    v_mfma_f32_16x16x32_bf16 v[96:99], a[48:51], v[80:83], v[96:99]
    v_mfma_f32_16x16x32_bf16 v[112:115], a[52:55], v[80:83], v[112:115]
    buffer_load_dwordx4 v12, s[60:63], s79 offen offset:1024 sc1 lds
    v_mfma_f32_16x16x32_bf16 v[128:131], a[56:59], v[80:83], v[128:131]
    v_mfma_f32_16x16x32_bf16 v[144:147], a[60:63], v[80:83], v[144:147]
    buffer_load_dwordx4 v[80:83], v17, s[60:63], s71 offen sc1
    v_mfma_f32_16x16x32_bf16 v[100:103], a[48:51], v[84:87], v[100:103]
    v_mfma_f32_16x16x32_bf16 v[116:119], a[52:55], v[84:87], v[116:119]
    buffer_load_dwordx4 v12, s[60:63], s79 offen offset:2048 sc1 lds
    v_mfma_f32_16x16x32_bf16 v[132:135], a[56:59], v[84:87], v[132:135]
    v_mfma_f32_16x16x32_bf16 v[148:151], a[60:63], v[84:87], v[148:151]
    buffer_load_dwordx4 v[84:87], v22, s[60:63], s71 offen sc1
    v_mfma_f32_16x16x32_bf16 v[104:107], a[48:51], v[88:91], v[104:107]
    v_mfma_f32_16x16x32_bf16 v[120:123], a[52:55], v[88:91], v[120:123]
    buffer_load_dwordx4 v12, s[60:63], s79 offen offset:3072 sc1 lds
    v_mfma_f32_16x16x32_bf16 v[136:139], a[56:59], v[88:91], v[136:139]
    v_mfma_f32_16x16x32_bf16 v[152:155], a[60:63], v[88:91], v[152:155]
    buffer_load_dwordx4 v[88:91], v23, s[60:63], s71 offen sc1
    s_waitcnt vmcnt(25)
    s_waitcnt vmcnt(63)
    v_mfma_f32_16x16x32_bf16 v[92:95], a[64:67], v[28:31], v[92:95]
    s_add_u32 s71, s38, 4096
    v_mfma_f32_16x16x32_bf16 v[108:111], a[68:71], v[28:31], v[108:111]
    s_add_u32 m0, s78, 4096
    s_add_u32 s79, s39, 40960
    buffer_load_dwordx4 v12, s[60:63], s79 offen offset:0 sc1 lds
    v_mfma_f32_16x16x32_bf16 v[124:127], a[72:75], v[28:31], v[124:127]
    v_mfma_f32_16x16x32_bf16 v[140:143], a[76:79], v[28:31], v[140:143]
    buffer_load_dwordx4 v[28:31], v16, s[60:63], s71 offen sc1
    v_mfma_f32_16x16x32_bf16 v[96:99], a[64:67], v[32:35], v[96:99]
    v_mfma_f32_16x16x32_bf16 v[112:115], a[68:71], v[32:35], v[112:115]
    buffer_load_dwordx4 v12, s[60:63], s79 offen offset:1024 sc1 lds
    v_mfma_f32_16x16x32_bf16 v[128:131], a[72:75], v[32:35], v[128:131]
    v_mfma_f32_16x16x32_bf16 v[144:147], a[76:79], v[32:35], v[144:147]
    buffer_load_dwordx4 v[32:35], v17, s[60:63], s71 offen sc1
    v_mfma_f32_16x16x32_bf16 v[100:103], a[64:67], v[36:39], v[100:103]
    v_mfma_f32_16x16x32_bf16 v[116:119], a[68:71], v[36:39], v[116:119]
    buffer_load_dwordx4 v12, s[60:63], s79 offen offset:2048 sc1 lds
    v_mfma_f32_16x16x32_bf16 v[132:135], a[72:75], v[36:39], v[132:135]
    v_mfma_f32_16x16x32_bf16 v[148:151], a[76:79], v[36:39], v[148:151]
    buffer_load_dwordx4 v[36:39], v22, s[60:63], s71 offen sc1
    v_mfma_f32_16x16x32_bf16 v[104:107], a[64:67], v[40:43], v[104:107]
    v_mfma_f32_16x16x32_bf16 v[120:123], a[68:71], v[40:43], v[120:123]
    buffer_load_dwordx4 v12, s[60:63], s79 offen offset:3072 sc1 lds
    v_mfma_f32_16x16x32_bf16 v[136:139], a[72:75], v[40:43], v[136:139]
    v_mfma_f32_16x16x32_bf16 v[152:155], a[76:79], v[40:43], v[152:155]
    buffer_load_dwordx4 v[40:43], v23, s[60:63], s71 offen sc1
    s_waitcnt vmcnt(24)
    s_waitcnt vmcnt(63)
    v_mfma_f32_16x16x32_bf16 v[92:95], a[80:83], v[44:47], v[92:95]
    s_add_u32 s71, s38, 8192
    v_mfma_f32_16x16x32_bf16 v[108:111], a[84:87], v[44:47], v[108:111]
    s_add_u32 m0, s78, 8192
    s_add_u32 s79, s39, 45056
    buffer_load_dwordx4 v12, s[60:63], s79 offen offset:0 sc1 lds
    v_mfma_f32_16x16x32_bf16 v[124:127], a[88:91], v[44:47], v[124:127]
    v_mfma_f32_16x16x32_bf16 v[140:143], a[92:95], v[44:47], v[140:143]
    buffer_load_dwordx4 v[44:47], v16, s[60:63], s71 offen sc1
    v_mfma_f32_16x16x32_bf16 v[96:99], a[80:83], v[48:51], v[96:99]
    v_mfma_f32_16x16x32_bf16 v[112:115], a[84:87], v[48:51], v[112:115]
    buffer_load_dwordx4 v12, s[60:63], s79 offen offset:1024 sc1 lds
    v_mfma_f32_16x16x32_bf16 v[128:131], a[88:91], v[48:51], v[128:131]
    v_mfma_f32_16x16x32_bf16 v[144:147], a[92:95], v[48:51], v[144:147]
    buffer_load_dwordx4 v[48:51], v17, s[60:63], s71 offen sc1
    v_mfma_f32_16x16x32_bf16 v[100:103], a[80:83], v[52:55], v[100:103]
    v_mfma_f32_16x16x32_bf16 v[116:119], a[84:87], v[52:55], v[116:119]
    buffer_load_dwordx4 v12, s[60:63], s79 offen offset:2048 sc1 lds
    v_mfma_f32_16x16x32_bf16 v[132:135], a[88:91], v[52:55], v[132:135]
    v_mfma_f32_16x16x32_bf16 v[148:151], a[92:95], v[52:55], v[148:151]
    buffer_load_dwordx4 v[52:55], v22, s[60:63], s71 offen sc1
    v_mfma_f32_16x16x32_bf16 v[104:107], a[80:83], v[56:59], v[104:107]
    v_mfma_f32_16x16x32_bf16 v[120:123], a[84:87], v[56:59], v[120:123]
    buffer_load_dwordx4 v12, s[60:63], s79 offen offset:3072 sc1 lds
    v_mfma_f32_16x16x32_bf16 v[136:139], a[88:91], v[56:59], v[136:139]
    v_mfma_f32_16x16x32_bf16 v[152:155], a[92:95], v[56:59], v[152:155]
    buffer_load_dwordx4 v[56:59], v23, s[60:63], s71 offen sc1
    s_waitcnt vmcnt(24)
    s_waitcnt vmcnt(63)
    v_mfma_f32_16x16x32_bf16 v[92:95], a[96:99], v[60:63], v[92:95]
    s_add_u32 s71, s38, 12288
    v_mfma_f32_16x16x32_bf16 v[108:111], a[100:103], v[60:63], v[108:111]
    s_add_u32 m0, s78, 12288
    s_add_u32 s79, s39, 49152
    buffer_load_dwordx4 v12, s[60:63], s79 offen offset:0 sc1 lds
    v_mfma_f32_16x16x32_bf16 v[124:127], a[104:107], v[60:63], v[124:127]
    v_mfma_f32_16x16x32_bf16 v[140:143], a[108:111], v[60:63], v[140:143]
    buffer_load_dwordx4 v[60:63], v16, s[60:63], s71 offen sc1
    v_mfma_f32_16x16x32_bf16 v[96:99], a[96:99], v[64:67], v[96:99]
    v_mfma_f32_16x16x32_bf16 v[112:115], a[100:103], v[64:67], v[112:115]
    buffer_load_dwordx4 v12, s[60:63], s79 offen offset:1024 sc1 lds
    v_mfma_f32_16x16x32_bf16 v[128:131], a[104:107], v[64:67], v[128:131]
    v_mfma_f32_16x16x32_bf16 v[144:147], a[108:111], v[64:67], v[144:147]
    buffer_load_dwordx4 v[64:67], v17, s[60:63], s71 offen sc1
    v_mfma_f32_16x16x32_bf16 v[100:103], a[96:99], v[68:71], v[100:103]
    v_mfma_f32_16x16x32_bf16 v[116:119], a[100:103], v[68:71], v[116:119]
    buffer_load_dwordx4 v12, s[60:63], s79 offen offset:2048 sc1 lds
    v_mfma_f32_16x16x32_bf16 v[132:135], a[104:107], v[68:71], v[132:135]
    v_mfma_f32_16x16x32_bf16 v[148:151], a[108:111], v[68:71], v[148:151]
    buffer_load_dwordx4 v[68:71], v22, s[60:63], s71 offen sc1
    v_mfma_f32_16x16x32_bf16 v[104:107], a[96:99], v[72:75], v[104:107]
    v_mfma_f32_16x16x32_bf16 v[120:123], a[100:103], v[72:75], v[120:123]
    buffer_load_dwordx4 v12, s[60:63], s79 offen offset:3072 sc1 lds
    v_mfma_f32_16x16x32_bf16 v[136:139], a[104:107], v[72:75], v[136:139]
    v_mfma_f32_16x16x32_bf16 v[152:155], a[108:111], v[72:75], v[152:155]
    buffer_load_dwordx4 v[72:75], v23, s[60:63], s71 offen sc1
    s_waitcnt vmcnt(24)
    s_waitcnt vmcnt(63)
    v_mfma_f32_16x16x32_bf16 v[156:159], a[112:115], v[76:79], 0
    s_add_u32 s71, s38, 16384
    v_mfma_f32_16x16x32_bf16 v[172:175], a[116:119], v[76:79], 0
    s_add_u32 m0, s78, 16384
    s_add_u32 s79, s39, 53248
    buffer_load_dwordx4 v12, s[60:63], s79 offen offset:0 sc1 lds
    v_mfma_f32_16x16x32_bf16 v[188:191], a[120:123], v[76:79], 0
    v_mfma_f32_16x16x32_bf16 v[204:207], a[124:127], v[76:79], 0
    buffer_load_dwordx4 v[76:79], v16, s[60:63], s71 offen sc1
    v_mfma_f32_16x16x32_bf16 v[160:163], a[112:115], v[80:83], 0
    v_mfma_f32_16x16x32_bf16 v[176:179], a[116:119], v[80:83], 0
    buffer_load_dwordx4 v12, s[60:63], s79 offen offset:1024 sc1 lds
    v_mfma_f32_16x16x32_bf16 v[192:195], a[120:123], v[80:83], 0
    v_mfma_f32_16x16x32_bf16 v[208:211], a[124:127], v[80:83], 0
    buffer_load_dwordx4 v[80:83], v17, s[60:63], s71 offen sc1
    v_mfma_f32_16x16x32_bf16 v[164:167], a[112:115], v[84:87], 0
    v_mfma_f32_16x16x32_bf16 v[180:183], a[116:119], v[84:87], 0
    buffer_load_dwordx4 v12, s[60:63], s79 offen offset:2048 sc1 lds
    v_mfma_f32_16x16x32_bf16 v[196:199], a[120:123], v[84:87], 0
    v_mfma_f32_16x16x32_bf16 v[212:215], a[124:127], v[84:87], 0
    buffer_load_dwordx4 v[84:87], v22, s[60:63], s71 offen sc1
    v_mfma_f32_16x16x32_bf16 v[168:171], a[112:115], v[88:91], 0
    v_mfma_f32_16x16x32_bf16 v[184:187], a[116:119], v[88:91], 0
    buffer_load_dwordx4 v12, s[60:63], s79 offen offset:3072 sc1 lds
    v_mfma_f32_16x16x32_bf16 v[200:203], a[120:123], v[88:91], 0
    v_mfma_f32_16x16x32_bf16 v[216:219], a[124:127], v[88:91], 0
    buffer_load_dwordx4 v[88:91], v23, s[60:63], s71 offen sc1
    s_waitcnt vmcnt(24)
    s_waitcnt vmcnt(63)
    v_mfma_f32_16x16x32_bf16 v[156:159], a[128:131], v[28:31], v[156:159]
    s_add_u32 s71, s38, 20480
    v_mfma_f32_16x16x32_bf16 v[172:175], a[132:135], v[28:31], v[172:175]
    ds_write_b128 v6, v[96:99] offset:0
    v_mfma_f32_16x16x32_bf16 v[188:191], a[136:139], v[28:31], v[188:191]
    ds_write_b128 v6, v[112:115] offset:1024
    v_mfma_f32_16x16x32_bf16 v[204:207], a[140:143], v[28:31], v[204:207]
    ds_write_b128 v6, v[128:131] offset:2048
    buffer_load_dwordx4 v[28:31], v16, s[60:63], s71 offen sc1
    v_mfma_f32_16x16x32_bf16 v[160:163], a[128:131], v[32:35], v[160:163]
    ds_write_b128 v6, v[144:147] offset:3072
    v_mfma_f32_16x16x32_bf16 v[176:179], a[132:135], v[32:35], v[176:179]
    v_mfma_f32_16x16x32_bf16 v[192:195], a[136:139], v[32:35], v[192:195]
    v_mfma_f32_16x16x32_bf16 v[208:211], a[140:143], v[32:35], v[208:211]
    buffer_load_dwordx4 v[32:35], v17, s[60:63], s71 offen sc1
    v_mfma_f32_16x16x32_bf16 v[164:167], a[128:131], v[36:39], v[164:167]
    v_mfma_f32_16x16x32_bf16 v[180:183], a[132:135], v[36:39], v[180:183]
    v_mfma_f32_16x16x32_bf16 v[196:199], a[136:139], v[36:39], v[196:199]
    v_mfma_f32_16x16x32_bf16 v[212:215], a[140:143], v[36:39], v[212:215]
    buffer_load_dwordx4 v[36:39], v22, s[60:63], s71 offen sc1
    v_mfma_f32_16x16x32_bf16 v[168:171], a[128:131], v[40:43], v[168:171]
    v_mfma_f32_16x16x32_bf16 v[184:187], a[132:135], v[40:43], v[184:187]
    v_mfma_f32_16x16x32_bf16 v[200:203], a[136:139], v[40:43], v[200:203]
    v_mfma_f32_16x16x32_bf16 v[216:219], a[140:143], v[40:43], v[216:219]
    buffer_load_dwordx4 v[40:43], v23, s[60:63], s71 offen sc1
    s_waitcnt vmcnt(20)
    s_waitcnt vmcnt(63)
    v_mfma_f32_16x16x32_bf16 v[156:159], a[144:147], v[44:47], v[156:159]
    s_add_u32 s71, s38, 24576
    v_mfma_f32_16x16x32_bf16 v[172:175], a[148:151], v[44:47], v[172:175]
    ds_write_b128 v7, v[100:103] offset:0
    v_mfma_f32_16x16x32_bf16 v[188:191], a[152:155], v[44:47], v[188:191]
    ds_write_b128 v7, v[116:119] offset:1024
    v_mfma_f32_16x16x32_bf16 v[204:207], a[156:159], v[44:47], v[204:207]
    ds_write_b128 v7, v[132:135] offset:2048
    buffer_load_dwordx4 v[44:47], v16, s[60:63], s71 offen sc1
    v_mfma_f32_16x16x32_bf16 v[160:163], a[144:147], v[48:51], v[160:163]
    ds_write_b128 v7, v[148:151] offset:3072
    v_mfma_f32_16x16x32_bf16 v[176:179], a[148:151], v[48:51], v[176:179]
    v_mfma_f32_16x16x32_bf16 v[192:195], a[152:155], v[48:51], v[192:195]
    v_mfma_f32_16x16x32_bf16 v[208:211], a[156:159], v[48:51], v[208:211]
    buffer_load_dwordx4 v[48:51], v17, s[60:63], s71 offen sc1
    v_mfma_f32_16x16x32_bf16 v[164:167], a[144:147], v[52:55], v[164:167]
    v_mfma_f32_16x16x32_bf16 v[180:183], a[148:151], v[52:55], v[180:183]
    v_mfma_f32_16x16x32_bf16 v[196:199], a[152:155], v[52:55], v[196:199]
    v_mfma_f32_16x16x32_bf16 v[212:215], a[156:159], v[52:55], v[212:215]
    buffer_load_dwordx4 v[52:55], v22, s[60:63], s71 offen sc1
    v_mfma_f32_16x16x32_bf16 v[168:171], a[144:147], v[56:59], v[168:171]
    v_mfma_f32_16x16x32_bf16 v[184:187], a[148:151], v[56:59], v[184:187]
    v_mfma_f32_16x16x32_bf16 v[200:203], a[152:155], v[56:59], v[200:203]
    v_mfma_f32_16x16x32_bf16 v[216:219], a[156:159], v[56:59], v[216:219]
    buffer_load_dwordx4 v[56:59], v23, s[60:63], s71 offen sc1
    s_waitcnt vmcnt(16)
    s_waitcnt vmcnt(63)
    v_mfma_f32_16x16x32_bf16 v[156:159], a[160:163], v[60:63], v[156:159]
    s_add_u32 s71, s38, 28672
    v_mfma_f32_16x16x32_bf16 v[172:175], a[164:167], v[60:63], v[172:175]
    ds_write_b128 v8, v[104:107] offset:0
    v_mfma_f32_16x16x32_bf16 v[188:191], a[168:171], v[60:63], v[188:191]
    ds_write_b128 v8, v[120:123] offset:1024
    v_mfma_f32_16x16x32_bf16 v[204:207], a[172:175], v[60:63], v[204:207]
    ds_write_b128 v8, v[136:139] offset:2048
    buffer_load_dwordx4 v[60:63], v16, s[60:63], s71 offen sc1
    v_mfma_f32_16x16x32_bf16 v[160:163], a[160:163], v[64:67], v[160:163]
    ds_write_b128 v8, v[152:155] offset:3072
    v_mfma_f32_16x16x32_bf16 v[176:179], a[164:167], v[64:67], v[176:179]
    v_mfma_f32_16x16x32_bf16 v[192:195], a[168:171], v[64:67], v[192:195]
    v_mfma_f32_16x16x32_bf16 v[208:211], a[172:175], v[64:67], v[208:211]
    buffer_load_dwordx4 v[64:67], v17, s[60:63], s71 offen sc1
    v_mfma_f32_16x16x32_bf16 v[164:167], a[160:163], v[68:71], v[164:167]
    v_mfma_f32_16x16x32_bf16 v[180:183], a[164:167], v[68:71], v[180:183]
    v_mfma_f32_16x16x32_bf16 v[196:199], a[168:171], v[68:71], v[196:199]
    v_mfma_f32_16x16x32_bf16 v[212:215], a[172:175], v[68:71], v[212:215]
    buffer_load_dwordx4 v[68:71], v22, s[60:63], s71 offen sc1
    v_mfma_f32_16x16x32_bf16 v[168:171], a[160:163], v[72:75], v[168:171]
    v_mfma_f32_16x16x32_bf16 v[184:187], a[164:167], v[72:75], v[184:187]
    v_mfma_f32_16x16x32_bf16 v[200:203], a[168:171], v[72:75], v[200:203]
    v_mfma_f32_16x16x32_bf16 v[216:219], a[172:175], v[72:75], v[216:219]
    buffer_load_dwordx4 v[72:75], v23, s[60:63], s71 offen sc1
    s_waitcnt vmcnt(12)
    s_waitcnt vmcnt(63)
    v_mfma_f32_16x16x32_bf16 v[156:159], a[176:179], v[76:79], v[156:159]
    s_add_u32 s71, s38, 32768
    v_mfma_f32_16x16x32_bf16 v[172:175], a[180:183], v[76:79], v[172:175]
    v_mfma_f32_16x16x32_bf16 v[188:191], a[184:187], v[76:79], v[188:191]
    v_mfma_f32_16x16x32_bf16 v[204:207], a[188:191], v[76:79], v[204:207]
    buffer_load_dwordx4 v[76:79], v16, s[60:63], s71 offen sc1
    v_mfma_f32_16x16x32_bf16 v[160:163], a[176:179], v[80:83], v[160:163]
    v_mfma_f32_16x16x32_bf16 v[176:179], a[180:183], v[80:83], v[176:179]
    v_mfma_f32_16x16x32_bf16 v[192:195], a[184:187], v[80:83], v[192:195]
    v_mfma_f32_16x16x32_bf16 v[208:211], a[188:191], v[80:83], v[208:211]
    buffer_load_dwordx4 v[80:83], v17, s[60:63], s71 offen sc1
    v_mfma_f32_16x16x32_bf16 v[164:167], a[176:179], v[84:87], v[164:167]
    v_mfma_f32_16x16x32_bf16 v[180:183], a[180:183], v[84:87], v[180:183]
    v_mfma_f32_16x16x32_bf16 v[196:199], a[184:187], v[84:87], v[196:199]
    v_mfma_f32_16x16x32_bf16 v[212:215], a[188:191], v[84:87], v[212:215]
    buffer_load_dwordx4 v[84:87], v22, s[60:63], s71 offen sc1
    v_mfma_f32_16x16x32_bf16 v[168:171], a[176:179], v[88:91], v[168:171]
    v_mfma_f32_16x16x32_bf16 v[184:187], a[180:183], v[88:91], v[184:187]
    v_mfma_f32_16x16x32_bf16 v[200:203], a[184:187], v[88:91], v[200:203]
    v_mfma_f32_16x16x32_bf16 v[216:219], a[188:191], v[88:91], v[216:219]
    buffer_load_dwordx4 v[88:91], v23, s[60:63], s71 offen sc1
    s_waitcnt lgkmcnt(0)
    s_barrier
    s_waitcnt vmcnt(12)
    s_waitcnt vmcnt(63)
    v_mfma_f32_16x16x32_bf16 v[156:159], a[192:195], v[28:31], v[156:159]
    s_add_u32 s71, s38, 36864
    v_mfma_f32_16x16x32_bf16 v[172:175], a[196:199], v[28:31], v[172:175]
    ds_read_b128 v[96:99], v13 offset:0
    v_mfma_f32_16x16x32_bf16 v[188:191], a[200:203], v[28:31], v[188:191]
    ds_read_b128 v[112:115], v13 offset:1024
    v_mfma_f32_16x16x32_bf16 v[204:207], a[204:207], v[28:31], v[204:207]
    ds_read_b128 v[128:131], v13 offset:2048
    buffer_load_dwordx4 v[28:31], v16, s[60:63], s71 offen sc1
    v_mfma_f32_16x16x32_bf16 v[160:163], a[192:195], v[32:35], v[160:163]
    ds_read_b128 v[144:147], v13 offset:3072
    v_mfma_f32_16x16x32_bf16 v[176:179], a[196:199], v[32:35], v[176:179]
    ds_read_b128 v[100:103], v13 offset:4096
    v_mfma_f32_16x16x32_bf16 v[192:195], a[200:203], v[32:35], v[192:195]
    ds_read_b128 v[116:119], v13 offset:5120
    v_mfma_f32_16x16x32_bf16 v[208:211], a[204:207], v[32:35], v[208:211]
    buffer_load_dwordx4 v[32:35], v17, s[60:63], s71 offen sc1
    v_mfma_f32_16x16x32_bf16 v[164:167], a[192:195], v[36:39], v[164:167]
    v_mfma_f32_16x16x32_bf16 v[180:183], a[196:199], v[36:39], v[180:183]
    v_mfma_f32_16x16x32_bf16 v[196:199], a[200:203], v[36:39], v[196:199]
    v_mfma_f32_16x16x32_bf16 v[212:215], a[204:207], v[36:39], v[212:215]
    buffer_load_dwordx4 v[36:39], v22, s[60:63], s71 offen sc1
    v_mfma_f32_16x16x32_bf16 v[168:171], a[192:195], v[40:43], v[168:171]
    v_mfma_f32_16x16x32_bf16 v[184:187], a[196:199], v[40:43], v[184:187]
    v_mfma_f32_16x16x32_bf16 v[200:203], a[200:203], v[40:43], v[200:203]
    v_mfma_f32_16x16x32_bf16 v[216:219], a[204:207], v[40:43], v[216:219]
    buffer_load_dwordx4 v[40:43], v23, s[60:63], s71 offen sc1
    s_waitcnt vmcnt(12)
    s_waitcnt vmcnt(63)
    v_mfma_f32_16x16x32_bf16 v[156:159], a[208:211], v[44:47], v[156:159]
    s_add_u32 s71, s38, 40960
    v_mfma_f32_16x16x32_bf16 v[172:175], a[212:215], v[44:47], v[172:175]
    ds_read_b128 v[132:135], v13 offset:6144
    v_mfma_f32_16x16x32_bf16 v[188:191], a[216:219], v[44:47], v[188:191]
    ds_read_b128 v[148:151], v13 offset:7168
    v_mfma_f32_16x16x32_bf16 v[204:207], a[220:223], v[44:47], v[204:207]
    ds_read_b128 v[104:107], v13 offset:8192
    buffer_load_dwordx4 v[44:47], v16, s[60:63], s71 offen sc1
    v_mfma_f32_16x16x32_bf16 v[160:163], a[208:211], v[48:51], v[160:163]
    ds_read_b128 v[120:123], v13 offset:9216
    v_mfma_f32_16x16x32_bf16 v[176:179], a[212:215], v[48:51], v[176:179]
    ds_read_b128 v[136:139], v13 offset:10240
    v_mfma_f32_16x16x32_bf16 v[192:195], a[216:219], v[48:51], v[192:195]
    ds_read_b128 v[152:155], v13 offset:11264
    v_mfma_f32_16x16x32_bf16 v[208:211], a[220:223], v[48:51], v[208:211]
    buffer_load_dwordx4 v[48:51], v17, s[60:63], s71 offen sc1
    v_mfma_f32_16x16x32_bf16 v[164:167], a[208:211], v[52:55], v[164:167]
    v_mfma_f32_16x16x32_bf16 v[180:183], a[212:215], v[52:55], v[180:183]
    v_mfma_f32_16x16x32_bf16 v[196:199], a[216:219], v[52:55], v[196:199]
    v_mfma_f32_16x16x32_bf16 v[212:215], a[220:223], v[52:55], v[212:215]
    buffer_load_dwordx4 v[52:55], v22, s[60:63], s71 offen sc1
    v_mfma_f32_16x16x32_bf16 v[168:171], a[208:211], v[56:59], v[168:171]
    v_mfma_f32_16x16x32_bf16 v[184:187], a[212:215], v[56:59], v[184:187]
    v_mfma_f32_16x16x32_bf16 v[200:203], a[216:219], v[56:59], v[200:203]
    v_mfma_f32_16x16x32_bf16 v[216:219], a[220:223], v[56:59], v[216:219]
    buffer_load_dwordx4 v[56:59], v23, s[60:63], s71 offen sc1
    s_waitcnt vmcnt(12)
    s_waitcnt vmcnt(63)
    v_mfma_f32_16x16x32_bf16 v[156:159], a[224:227], v[60:63], v[156:159]
    s_add_u32 s71, s38, 45056
    s_waitcnt lgkmcnt(8)
    v_add_f32 v92, v92, v96
    v_add_f32 v93, v93, v97
    v_mfma_f32_16x16x32_bf16 v[172:175], a[228:231], v[60:63], v[172:175]
    v_add_f32 v94, v94, v98
    v_add_f32 v95, v95, v99
    v_add_f32 v108, v108, v112
    v_mfma_f32_16x16x32_bf16 v[188:191], a[232:235], v[60:63], v[188:191]
    v_add_f32 v109, v109, v113
    v_add_f32 v110, v110, v114
    v_add_f32 v111, v111, v115
    v_mfma_f32_16x16x32_bf16 v[204:207], a[236:239], v[60:63], v[204:207]
    buffer_load_dwordx4 v[60:63], v16, s[60:63], s71 offen sc1
    v_add_f32 v124, v124, v128
    v_add_f32 v125, v125, v129
    v_mfma_f32_16x16x32_bf16 v[160:163], a[224:227], v[64:67], v[160:163]
    v_add_f32 v126, v126, v130
    v_add_f32 v127, v127, v131
    v_add_f32 v140, v140, v144
    v_mfma_f32_16x16x32_bf16 v[176:179], a[228:231], v[64:67], v[176:179]
    v_add_f32 v141, v141, v145
    v_add_f32 v142, v142, v146
    v_add_f32 v143, v143, v147
    v_mfma_f32_16x16x32_bf16 v[192:195], a[232:235], v[64:67], v[192:195]
    s_waitcnt lgkmcnt(4)
    v_add_f32 v92, v92, v100
    v_add_f32 v93, v93, v101
    v_add_f32 v94, v94, v102
    v_mfma_f32_16x16x32_bf16 v[208:211], a[236:239], v[64:67], v[208:211]
    buffer_load_dwordx4 v[64:67], v17, s[60:63], s71 offen sc1
    v_add_f32 v95, v95, v103
    v_add_f32 v108, v108, v116
    v_mfma_f32_16x16x32_bf16 v[164:167], a[224:227], v[68:71], v[164:167]
    v_add_f32 v109, v109, v117
    v_add_f32 v110, v110, v118
    v_add_f32 v111, v111, v119
    v_mfma_f32_16x16x32_bf16 v[180:183], a[228:231], v[68:71], v[180:183]
    v_add_f32 v124, v124, v132
    v_add_f32 v125, v125, v133
    v_add_f32 v126, v126, v134
    v_mfma_f32_16x16x32_bf16 v[196:199], a[232:235], v[68:71], v[196:199]
    v_add_f32 v127, v127, v135
    v_add_f32 v140, v140, v148
    v_add_f32 v141, v141, v149
    v_mfma_f32_16x16x32_bf16 v[212:215], a[236:239], v[68:71], v[212:215]
    buffer_load_dwordx4 v[68:71], v22, s[60:63], s71 offen sc1
    v_add_f32 v142, v142, v150
    v_add_f32 v143, v143, v151
    v_mfma_f32_16x16x32_bf16 v[168:171], a[224:227], v[72:75], v[168:171]
    s_waitcnt lgkmcnt(0)
    v_add_f32 v92, v92, v104
    v_add_f32 v93, v93, v105
    v_add_f32 v94, v94, v106
    v_mfma_f32_16x16x32_bf16 v[184:187], a[228:231], v[72:75], v[184:187]
    v_add_f32 v95, v95, v107
    v_add_f32 v108, v108, v120
    v_add_f32 v109, v109, v121
    v_mfma_f32_16x16x32_bf16 v[200:203], a[232:235], v[72:75], v[200:203]
    v_add_f32 v110, v110, v122
    v_add_f32 v111, v111, v123
    v_add_f32 v124, v124, v136
    v_mfma_f32_16x16x32_bf16 v[216:219], a[236:239], v[72:75], v[216:219]
    buffer_load_dwordx4 v[72:75], v23, s[60:63], s71 offen sc1
    v_add_f32 v125, v125, v137
    v_add_f32 v126, v126, v138
    s_waitcnt vmcnt(12)
    s_waitcnt vmcnt(63)
    s_waitcnt vmcnt(29)
    v_mfma_f32_16x16x32_bf16 v[156:159], a[240:243], v[76:79], v[156:159]
    s_add_u32 s71, s38, 49152
    v_mfma_f32_16x16x32_bf16 v[172:175], a[244:247], v[76:79], v[172:175]
    ds_read_b128 a[0:3], v21 offset:0
    v_mfma_f32_16x16x32_bf16 v[188:191], a[248:251], v[76:79], v[188:191]
    ds_read_b128 a[4:7], v21 offset:1024
    v_mfma_f32_16x16x32_bf16 v[204:207], a[252:255], v[76:79], v[204:207]
    ds_read_b128 a[8:11], v21 offset:2048
    buffer_load_dwordx4 v[76:79], v16, s[60:63], s71 offen sc1
    v_mfma_f32_16x16x32_bf16 v[160:163], a[240:243], v[80:83], v[160:163]
    ds_read_b128 a[12:15], v21 offset:3072
    v_add_f32 v127, v127, v139
    v_add_f32 v140, v140, v152
    v_mfma_f32_16x16x32_bf16 v[176:179], a[244:247], v[80:83], v[176:179]
    v_add_f32 v141, v141, v153
    v_add_f32 v142, v142, v154
    v_add_f32 v143, v143, v155
    v_mfma_f32_16x16x32_bf16 v[192:195], a[248:251], v[80:83], v[192:195]
    s_waitcnt vmcnt(63)
    s_waitcnt lgkmcnt(15)
    v_lshlrev_b32 v96, 16, v226
    v_and_b32 v97, 0xffff0000, v226
    v_lshlrev_b32 v104, 16, v242
    v_mfma_f32_16x16x32_bf16 v[208:211], a[252:255], v[80:83], v[208:211]
    buffer_load_dwordx4 v[80:83], v17, s[60:63], s71 offen sc1
    v_and_b32 v105, 0xffff0000, v242
    v_sub_f32 v100, v96, v250
    v_mfma_f32_16x16x32_bf16 v[164:167], a[240:243], v[84:87], v[164:167]
    v_sub_f32 v101, v97, v250
    v_cvt_pk_bf16_f32 v9, v100, v101
    v_lshlrev_b32 v100, 16, v9
    v_mfma_f32_16x16x32_bf16 v[180:183], a[244:247], v[84:87], v[180:183]
    v_and_b32 v101, 0xffff0000, v9
    v_mul_f32 v100, v100, v251
    v_mul_f32 v101, v101, v251
    v_mfma_f32_16x16x32_bf16 v[196:199], a[248:251], v[84:87], v[196:199]
    v_cvt_pk_bf16_f32 v9, v100, v101
    v_lshlrev_b32 v100, 16, v9
    v_and_b32 v101, 0xffff0000, v9
    v_mfma_f32_16x16x32_bf16 v[212:215], a[252:255], v[84:87], v[212:215]
    buffer_load_dwordx4 v[84:87], v22, s[60:63], s71 offen sc1
    v_mul_f32 v100, v100, v104
    v_mul_f32 v101, v101, v105
    v_mfma_f32_16x16x32_bf16 v[168:171], a[240:243], v[88:91], v[168:171]
    v_cvt_pk_bf16_f32 v9, v100, v101
    v_lshlrev_b32 v100, 16, v9
    v_and_b32 v101, 0xffff0000, v9
    v_mfma_f32_16x16x32_bf16 v[184:187], a[244:247], v[88:91], v[184:187]
    v_add_f32 v92, v92, v100
    v_add_f32 v93, v93, v101
    v_lshlrev_b32 v98, 16, v227
    v_mfma_f32_16x16x32_bf16 v[200:203], a[248:251], v[88:91], v[200:203]
    v_and_b32 v99, 0xffff0000, v227
    v_lshlrev_b32 v106, 16, v243
    v_and_b32 v107, 0xffff0000, v243
    v_mfma_f32_16x16x32_bf16 v[216:219], a[252:255], v[88:91], v[216:219]
    buffer_load_dwordx4 v[88:91], v23, s[60:63], s71 offen sc1
    v_sub_f32 v102, v98, v250
    v_sub_f32 v103, v99, v250
    s_waitcnt vmcnt(12) lgkmcnt(0)
    v_mfma_f32_16x16x32_bf16 v[156:159], a[0:3], v[28:31], v[156:159]
    s_add_u32 s71, s38, 53248
    v_mfma_f32_16x16x32_bf16 v[172:175], a[4:7], v[28:31], v[172:175]
    ds_read_b128 a[16:19], v21 offset:4096
    v_mfma_f32_16x16x32_bf16 v[188:191], a[8:11], v[28:31], v[188:191]
    ds_read_b128 a[20:23], v21 offset:5120
    v_mfma_f32_16x16x32_bf16 v[204:207], a[12:15], v[28:31], v[204:207]
    ds_read_b128 a[24:27], v21 offset:6144
    buffer_load_dwordx4 v[28:31], v16, s[60:63], s71 offen sc1
    v_mfma_f32_16x16x32_bf16 v[160:163], a[0:3], v[32:35], v[160:163]
    ds_read_b128 a[28:31], v21 offset:7168
    v_cvt_pk_bf16_f32 v10, v102, v103
    v_lshlrev_b32 v102, 16, v10
    v_mfma_f32_16x16x32_bf16 v[176:179], a[4:7], v[32:35], v[176:179]
    v_and_b32 v103, 0xffff0000, v10
    v_mul_f32 v102, v102, v251
    v_mul_f32 v103, v103, v251
    v_mfma_f32_16x16x32_bf16 v[192:195], a[8:11], v[32:35], v[192:195]
    v_cvt_pk_bf16_f32 v10, v102, v103
    v_lshlrev_b32 v102, 16, v10
    v_and_b32 v103, 0xffff0000, v10
    v_mfma_f32_16x16x32_bf16 v[208:211], a[12:15], v[32:35], v[208:211]
    buffer_load_dwordx4 v[32:35], v17, s[60:63], s71 offen sc1
    v_mul_f32 v102, v102, v106
    v_mul_f32 v103, v103, v107
    v_mfma_f32_16x16x32_bf16 v[164:167], a[0:3], v[36:39], v[164:167]
    v_cvt_pk_bf16_f32 v10, v102, v103
    v_lshlrev_b32 v102, 16, v10
    v_and_b32 v103, 0xffff0000, v10
    v_mfma_f32_16x16x32_bf16 v[180:183], a[4:7], v[36:39], v[180:183]
    v_add_f32 v94, v94, v102
    v_add_f32 v95, v95, v103
    v_lshlrev_b32 v112, 16, v228
    v_mfma_f32_16x16x32_bf16 v[196:199], a[8:11], v[36:39], v[196:199]
    v_and_b32 v113, 0xffff0000, v228
    v_lshlrev_b32 v120, 16, v244
    v_and_b32 v121, 0xffff0000, v244
    v_mfma_f32_16x16x32_bf16 v[212:215], a[12:15], v[36:39], v[212:215]
    buffer_load_dwordx4 v[36:39], v22, s[60:63], s71 offen sc1
    v_sub_f32 v116, v112, v250
    v_sub_f32 v117, v113, v250
    v_mfma_f32_16x16x32_bf16 v[168:171], a[0:3], v[40:43], v[168:171]
    v_cvt_pk_bf16_f32 v9, v116, v117
    v_lshlrev_b32 v116, 16, v9
    v_and_b32 v117, 0xffff0000, v9
    v_mfma_f32_16x16x32_bf16 v[184:187], a[4:7], v[40:43], v[184:187]
    v_mul_f32 v116, v116, v251
    v_mul_f32 v117, v117, v251
    v_cvt_pk_bf16_f32 v9, v116, v117
    v_mfma_f32_16x16x32_bf16 v[200:203], a[8:11], v[40:43], v[200:203]
    v_lshlrev_b32 v116, 16, v9
    v_and_b32 v117, 0xffff0000, v9
    v_mul_f32 v116, v116, v120
    v_mfma_f32_16x16x32_bf16 v[216:219], a[12:15], v[40:43], v[216:219]
    buffer_load_dwordx4 v[40:43], v23, s[60:63], s71 offen sc1
    v_mul_f32 v117, v117, v121
    v_cvt_pk_bf16_f32 v9, v116, v117
    s_waitcnt vmcnt(12) lgkmcnt(0)
    v_mfma_f32_16x16x32_bf16 v[156:159], a[16:19], v[44:47], v[156:159]
    ds_read_b128 a[0:3], v21 offset:8192
    v_mfma_f32_16x16x32_bf16 v[172:175], a[20:23], v[44:47], v[172:175]
    ds_read_b128 a[4:7], v21 offset:9216
    v_mfma_f32_16x16x32_bf16 v[188:191], a[24:27], v[44:47], v[188:191]
    ds_read_b128 a[8:11], v21 offset:10240
    v_mfma_f32_16x16x32_bf16 v[204:207], a[28:31], v[44:47], v[204:207]
    ds_read_b128 a[12:15], v21 offset:11264
    v_lshlrev_b32 v116, 16, v9
    v_and_b32 v117, 0xffff0000, v9
    v_mfma_f32_16x16x32_bf16 v[160:163], a[16:19], v[48:51], v[160:163]
    v_add_f32 v108, v108, v116
    v_add_f32 v109, v109, v117
    v_lshlrev_b32 v114, 16, v229
    v_mfma_f32_16x16x32_bf16 v[176:179], a[20:23], v[48:51], v[176:179]
    v_and_b32 v115, 0xffff0000, v229
    v_lshlrev_b32 v122, 16, v245
    v_and_b32 v123, 0xffff0000, v245
    v_mfma_f32_16x16x32_bf16 v[192:195], a[24:27], v[48:51], v[192:195]
    v_sub_f32 v118, v114, v250
    v_sub_f32 v119, v115, v250
    v_cvt_pk_bf16_f32 v10, v118, v119
    v_mfma_f32_16x16x32_bf16 v[208:211], a[28:31], v[48:51], v[208:211]
    v_lshlrev_b32 v118, 16, v10
    v_and_b32 v119, 0xffff0000, v10
    v_mul_f32 v118, v118, v251
    v_mfma_f32_16x16x32_bf16 v[164:167], a[16:19], v[52:55], v[164:167]
    v_mul_f32 v119, v119, v251
    v_cvt_pk_bf16_f32 v10, v118, v119
    v_lshlrev_b32 v118, 16, v10
    v_mfma_f32_16x16x32_bf16 v[180:183], a[20:23], v[52:55], v[180:183]
    v_and_b32 v119, 0xffff0000, v10
    v_mul_f32 v118, v118, v122
    v_mul_f32 v119, v119, v123
    v_mfma_f32_16x16x32_bf16 v[196:199], a[24:27], v[52:55], v[196:199]
    v_cvt_pk_bf16_f32 v10, v118, v119
    v_lshlrev_b32 v118, 16, v10
    v_and_b32 v119, 0xffff0000, v10
    v_mfma_f32_16x16x32_bf16 v[212:215], a[28:31], v[52:55], v[212:215]
    v_add_f32 v110, v110, v118
    v_add_f32 v111, v111, v119
    v_lshlrev_b32 v128, 16, v230
    v_mfma_f32_16x16x32_bf16 v[168:171], a[16:19], v[56:59], v[168:171]
    v_and_b32 v129, 0xffff0000, v230
    v_lshlrev_b32 v136, 16, v246
    v_and_b32 v137, 0xffff0000, v246
    v_mfma_f32_16x16x32_bf16 v[184:187], a[20:23], v[56:59], v[184:187]
    v_sub_f32 v132, v128, v250
    v_sub_f32 v133, v129, v250
    v_cvt_pk_bf16_f32 v9, v132, v133
    v_mfma_f32_16x16x32_bf16 v[200:203], a[24:27], v[56:59], v[200:203]
    v_lshlrev_b32 v132, 16, v9
    v_and_b32 v133, 0xffff0000, v9
    v_mul_f32 v132, v132, v251
    v_mfma_f32_16x16x32_bf16 v[216:219], a[28:31], v[56:59], v[216:219]
    v_mul_f32 v133, v133, v251
    v_cvt_pk_bf16_f32 v9, v132, v133
    v_lshlrev_b32 v132, 16, v9
    s_waitcnt vmcnt(8) lgkmcnt(0)
    v_mfma_f32_16x16x32_bf16 v[156:159], a[0:3], v[60:63], v[156:159]
    ds_read_b128 a[16:19], v21 offset:12288
    v_mfma_f32_16x16x32_bf16 v[172:175], a[4:7], v[60:63], v[172:175]
    ds_read_b128 a[20:23], v21 offset:13312
    v_mfma_f32_16x16x32_bf16 v[188:191], a[8:11], v[60:63], v[188:191]
    ds_read_b128 a[24:27], v21 offset:14336
    v_mfma_f32_16x16x32_bf16 v[204:207], a[12:15], v[60:63], v[204:207]
    ds_read_b128 a[28:31], v21 offset:15360
    v_and_b32 v133, 0xffff0000, v9
    v_mul_f32 v132, v132, v136
    v_mfma_f32_16x16x32_bf16 v[160:163], a[0:3], v[64:67], v[160:163]
    v_mul_f32 v133, v133, v137
    v_cvt_pk_bf16_f32 v9, v132, v133
    v_lshlrev_b32 v132, 16, v9
    v_mfma_f32_16x16x32_bf16 v[176:179], a[4:7], v[64:67], v[176:179]
    v_and_b32 v133, 0xffff0000, v9
    v_add_f32 v124, v124, v132
    v_add_f32 v125, v125, v133
    v_mfma_f32_16x16x32_bf16 v[192:195], a[8:11], v[64:67], v[192:195]
    v_lshlrev_b32 v130, 16, v231
    v_and_b32 v131, 0xffff0000, v231
    v_lshlrev_b32 v138, 16, v247
    v_mfma_f32_16x16x32_bf16 v[208:211], a[12:15], v[64:67], v[208:211]
    v_and_b32 v139, 0xffff0000, v247
    v_sub_f32 v134, v130, v250
    v_sub_f32 v135, v131, v250
    v_mfma_f32_16x16x32_bf16 v[164:167], a[0:3], v[68:71], v[164:167]
    v_cvt_pk_bf16_f32 v10, v134, v135
    v_lshlrev_b32 v134, 16, v10
    v_and_b32 v135, 0xffff0000, v10
    v_mfma_f32_16x16x32_bf16 v[180:183], a[4:7], v[68:71], v[180:183]
    v_mul_f32 v134, v134, v251
    v_mul_f32 v135, v135, v251
    v_cvt_pk_bf16_f32 v10, v134, v135
    v_mfma_f32_16x16x32_bf16 v[196:199], a[8:11], v[68:71], v[196:199]
    v_lshlrev_b32 v134, 16, v10
    v_and_b32 v135, 0xffff0000, v10
    v_mul_f32 v134, v134, v138
    v_mfma_f32_16x16x32_bf16 v[212:215], a[12:15], v[68:71], v[212:215]
    v_mul_f32 v135, v135, v139
    v_cvt_pk_bf16_f32 v10, v134, v135
    v_lshlrev_b32 v134, 16, v10
    v_mfma_f32_16x16x32_bf16 v[168:171], a[0:3], v[72:75], v[168:171]
    v_and_b32 v135, 0xffff0000, v10
    v_add_f32 v126, v126, v134
    v_add_f32 v127, v127, v135
    v_mfma_f32_16x16x32_bf16 v[184:187], a[4:7], v[72:75], v[184:187]
    v_lshlrev_b32 v144, 16, v232
    v_and_b32 v145, 0xffff0000, v232
    v_lshlrev_b32 v152, 16, v248
    v_mfma_f32_16x16x32_bf16 v[200:203], a[8:11], v[72:75], v[200:203]
    v_and_b32 v153, 0xffff0000, v248
    v_sub_f32 v148, v144, v250
    v_sub_f32 v149, v145, v250
    v_mfma_f32_16x16x32_bf16 v[216:219], a[12:15], v[72:75], v[216:219]
    v_cvt_pk_bf16_f32 v9, v148, v149
    v_lshlrev_b32 v148, 16, v9
    v_and_b32 v149, 0xffff0000, v9
    s_waitcnt vmcnt(4) lgkmcnt(0)
    v_mfma_f32_16x16x32_bf16 v[156:159], a[16:19], v[76:79], v[156:159]
    ds_read_b128 a[0:3], v21 offset:16384
    v_mfma_f32_16x16x32_bf16 v[172:175], a[20:23], v[76:79], v[172:175]
    ds_read_b128 a[4:7], v21 offset:17408
    v_mfma_f32_16x16x32_bf16 v[188:191], a[24:27], v[76:79], v[188:191]
    ds_read_b128 a[8:11], v21 offset:18432
    v_mfma_f32_16x16x32_bf16 v[204:207], a[28:31], v[76:79], v[204:207]
    ds_read_b128 a[12:15], v21 offset:19456
    v_mul_f32 v148, v148, v251
    v_mul_f32 v149, v149, v251
    v_mfma_f32_16x16x32_bf16 v[160:163], a[16:19], v[80:83], v[160:163]
    v_cvt_pk_bf16_f32 v9, v148, v149
    v_lshlrev_b32 v148, 16, v9
    v_and_b32 v149, 0xffff0000, v9
    v_mfma_f32_16x16x32_bf16 v[176:179], a[20:23], v[80:83], v[176:179]
    v_mul_f32 v148, v148, v152
    v_mul_f32 v149, v149, v153
    v_cvt_pk_bf16_f32 v9, v148, v149
    v_mfma_f32_16x16x32_bf16 v[192:195], a[24:27], v[80:83], v[192:195]
    v_lshlrev_b32 v148, 16, v9
    v_and_b32 v149, 0xffff0000, v9
    v_add_f32 v140, v140, v148
    v_mfma_f32_16x16x32_bf16 v[208:211], a[28:31], v[80:83], v[208:211]
    v_add_f32 v141, v141, v149
    v_lshlrev_b32 v146, 16, v233
    v_and_b32 v147, 0xffff0000, v233
    v_mfma_f32_16x16x32_bf16 v[164:167], a[16:19], v[84:87], v[164:167]
    v_lshlrev_b32 v154, 16, v249
    v_and_b32 v155, 0xffff0000, v249
    v_sub_f32 v150, v146, v250
    v_mfma_f32_16x16x32_bf16 v[180:183], a[20:23], v[84:87], v[180:183]
    v_sub_f32 v151, v147, v250
    v_cvt_pk_bf16_f32 v10, v150, v151
    v_lshlrev_b32 v150, 16, v10
    v_mfma_f32_16x16x32_bf16 v[196:199], a[24:27], v[84:87], v[196:199]
    v_and_b32 v151, 0xffff0000, v10
    v_mul_f32 v150, v150, v251
    v_mul_f32 v151, v151, v251
    v_mfma_f32_16x16x32_bf16 v[212:215], a[28:31], v[84:87], v[212:215]
    v_cvt_pk_bf16_f32 v10, v150, v151
    v_lshlrev_b32 v150, 16, v10
    v_and_b32 v151, 0xffff0000, v10
    v_mfma_f32_16x16x32_bf16 v[168:171], a[16:19], v[88:91], v[168:171]
    v_mul_f32 v150, v150, v154
    v_mul_f32 v151, v151, v155
    v_cvt_pk_bf16_f32 v10, v150, v151
    v_mfma_f32_16x16x32_bf16 v[184:187], a[20:23], v[88:91], v[184:187]
    v_lshlrev_b32 v150, 16, v10
    v_and_b32 v151, 0xffff0000, v10
    v_add_f32 v142, v142, v150
    v_mfma_f32_16x16x32_bf16 v[200:203], a[24:27], v[88:91], v[200:203]
    v_add_f32 v143, v143, v151
    v_mfma_f32_16x16x32_bf16 v[216:219], a[28:31], v[88:91], v[216:219]
    s_waitcnt vmcnt(0) lgkmcnt(0)
    v_mfma_f32_16x16x32_bf16 v[156:159], a[0:3], v[28:31], v[156:159]
    v_mfma_f32_16x16x32_bf16 v[172:175], a[4:7], v[28:31], v[172:175]
    v_mfma_f32_16x16x32_bf16 v[188:191], a[8:11], v[28:31], v[188:191]
    v_mfma_f32_16x16x32_bf16 v[204:207], a[12:15], v[28:31], v[204:207]
    v_mfma_f32_16x16x32_bf16 v[160:163], a[0:3], v[32:35], v[160:163]
    v_mfma_f32_16x16x32_bf16 v[176:179], a[4:7], v[32:35], v[176:179]
    v_mfma_f32_16x16x32_bf16 v[192:195], a[8:11], v[32:35], v[192:195]
    v_mfma_f32_16x16x32_bf16 v[208:211], a[12:15], v[32:35], v[208:211]
    v_mfma_f32_16x16x32_bf16 v[164:167], a[0:3], v[36:39], v[164:167]
    v_mfma_f32_16x16x32_bf16 v[180:183], a[4:7], v[36:39], v[180:183]
    v_mfma_f32_16x16x32_bf16 v[196:199], a[8:11], v[36:39], v[196:199]
    v_mfma_f32_16x16x32_bf16 v[212:215], a[12:15], v[36:39], v[212:215]
    v_mfma_f32_16x16x32_bf16 v[168:171], a[0:3], v[40:43], v[168:171]
    v_mfma_f32_16x16x32_bf16 v[184:187], a[4:7], v[40:43], v[184:187]
    v_mfma_f32_16x16x32_bf16 v[200:203], a[8:11], v[40:43], v[200:203]
    v_mfma_f32_16x16x32_bf16 v[216:219], a[12:15], v[40:43], v[216:219]
    s_waitcnt lgkmcnt(0)
    s_barrier
    ds_write_b128 v6, v[160:163] offset:0
    ds_write_b128 v6, v[176:179] offset:1024
    ds_write_b128 v6, v[192:195] offset:2048
    ds_write_b128 v6, v[208:211] offset:3072
    ds_write_b128 v7, v[164:167] offset:0
    ds_write_b128 v7, v[180:183] offset:1024
    ds_write_b128 v7, v[196:199] offset:2048
    ds_write_b128 v7, v[212:215] offset:3072
    ds_write_b128 v8, v[168:171] offset:0
    ds_write_b128 v8, v[184:187] offset:1024
    ds_write_b128 v8, v[200:203] offset:2048
    ds_write_b128 v8, v[216:219] offset:3072
    s_waitcnt lgkmcnt(0)
    s_barrier
    ds_read_b128 v[160:163], v13 offset:0
    ds_read_b128 v[176:179], v13 offset:1024
    ds_read_b128 v[192:195], v13 offset:2048
    ds_read_b128 v[208:211], v13 offset:3072
    ds_read_b128 v[164:167], v13 offset:4096
    ds_read_b128 v[180:183], v13 offset:5120
    ds_read_b128 v[196:199], v13 offset:6144
    ds_read_b128 v[212:215], v13 offset:7168
    ds_read_b128 v[168:171], v13 offset:8192
    ds_read_b128 v[184:187], v13 offset:9216
    ds_read_b128 v[200:203], v13 offset:10240
    ds_read_b128 v[216:219], v13 offset:11264
    v_mov_b32 v24, 0xbfb8aa3b
    v_mov_b32 v25, 1.0
    v_lshlrev_b32 v19, 1, v19
    s_waitcnt lgkmcnt(8)
    s_nop 0
    v_pk_add_f32 v[156:157], v[156:157], v[160:161]
    v_pk_add_f32 v[158:159], v[158:159], v[162:163]
    v_pk_add_f32 v[172:173], v[172:173], v[176:177]
    v_pk_add_f32 v[174:175], v[174:175], v[178:179]
    v_pk_add_f32 v[188:189], v[188:189], v[192:193]
    v_pk_add_f32 v[190:191], v[190:191], v[194:195]
    v_pk_add_f32 v[204:205], v[204:205], v[208:209]
    v_pk_add_f32 v[206:207], v[206:207], v[210:211]
    s_waitcnt lgkmcnt(4)
    s_nop 0
    v_pk_add_f32 v[156:157], v[156:157], v[164:165]
    v_pk_add_f32 v[158:159], v[158:159], v[166:167]
    v_pk_add_f32 v[172:173], v[172:173], v[180:181]
    v_pk_add_f32 v[174:175], v[174:175], v[182:183]
    v_pk_add_f32 v[188:189], v[188:189], v[196:197]
    v_pk_add_f32 v[190:191], v[190:191], v[198:199]
    v_pk_add_f32 v[204:205], v[204:205], v[212:213]
    v_pk_add_f32 v[206:207], v[206:207], v[214:215]
    s_waitcnt lgkmcnt(0)
    s_nop 0
    v_pk_add_f32 v[156:157], v[156:157], v[168:169]
    v_pk_add_f32 v[158:159], v[158:159], v[170:171]
    v_pk_add_f32 v[172:173], v[172:173], v[184:185]
    v_pk_add_f32 v[174:175], v[174:175], v[186:187]
    v_pk_add_f32 v[188:189], v[188:189], v[200:201]
    v_pk_add_f32 v[190:191], v[190:191], v[202:203]
    v_pk_add_f32 v[204:205], v[204:205], v[216:217]
    v_pk_add_f32 v[206:207], v[206:207], v[218:219]
    v_cvt_pk_bf16_f32 v34, v156, v157
    v_cvt_pk_bf16_f32 v42, v158, v159
    v_lshlrev_b32 v28, 16, v234
    v_lshlrev_b32 v36, 16, v235
    v_and_b32 v29, 0xffff0000, v234
    v_and_b32 v37, 0xffff0000, v235
    v_lshlrev_b32 v156, 16, v34
    v_lshlrev_b32 v158, 16, v42
    v_and_b32 v157, 0xffff0000, v34
    v_and_b32 v159, 0xffff0000, v42
    v_pk_add_f32 v[30:31], v[156:157], v[28:29]
    v_pk_add_f32 v[38:39], v[158:159], v[36:37]
    v_cvt_pk_bf16_f32 v34, v30, v31
    v_cvt_pk_bf16_f32 v42, v38, v39
    v_lshlrev_b32 v30, 16, v34
    v_lshlrev_b32 v38, 16, v42
    v_and_b32 v31, 0xffff0000, v34
    v_and_b32 v39, 0xffff0000, v42
    v_pk_mul_f32 v[32:33], v[30:31], v[24:25] op_sel_hi:[1,0]
    v_pk_mul_f32 v[40:41], v[38:39], v[24:25] op_sel_hi:[1,0]
    v_exp_f32 v32, v32
    v_exp_f32 v33, v33
    v_exp_f32 v40, v40
    v_exp_f32 v41, v41
    v_pk_add_f32 v[32:33], v[32:33], v[24:25] op_sel:[0,1] op_sel_hi:[1,1]
    v_pk_add_f32 v[40:41], v[40:41], v[24:25] op_sel:[0,1] op_sel_hi:[1,1]
    v_rcp_f32 v32, v32
    v_rcp_f32 v33, v33
    v_rcp_f32 v40, v40
    v_rcp_f32 v41, v41
    v_pk_mul_f32 v[30:31], v[30:31], v[32:33]
    v_pk_mul_f32 v[38:39], v[38:39], v[40:41]
    v_cvt_pk_bf16_f32 v34, v30, v31
    v_cvt_pk_bf16_f32 v42, v38, v39
    v_lshlrev_b32 v30, 16, v34
    v_lshlrev_b32 v38, 16, v42
    v_and_b32 v31, 0xffff0000, v34
    v_and_b32 v39, 0xffff0000, v42
    v_pk_fma_f32 v[160:161], v[92:93], v[30:31], v[96:97]
    v_pk_fma_f32 v[162:163], v[94:95], v[38:39], v[98:99]
    buffer_store_dwordx4 v[160:163], v19, s[72:75], 0 offen offset:0 sc1
    v_cvt_pk_bf16_f32 v34, v172, v173
    v_cvt_pk_bf16_f32 v42, v174, v175
    v_lshlrev_b32 v28, 16, v236
    v_lshlrev_b32 v36, 16, v237
    v_and_b32 v29, 0xffff0000, v236
    v_and_b32 v37, 0xffff0000, v237
    v_lshlrev_b32 v172, 16, v34
    v_lshlrev_b32 v174, 16, v42
    v_and_b32 v173, 0xffff0000, v34
    v_and_b32 v175, 0xffff0000, v42
    v_pk_add_f32 v[30:31], v[172:173], v[28:29]
    v_pk_add_f32 v[38:39], v[174:175], v[36:37]
    v_cvt_pk_bf16_f32 v34, v30, v31
    v_cvt_pk_bf16_f32 v42, v38, v39
    v_lshlrev_b32 v30, 16, v34
    v_lshlrev_b32 v38, 16, v42
    v_and_b32 v31, 0xffff0000, v34
    v_and_b32 v39, 0xffff0000, v42
    v_pk_mul_f32 v[32:33], v[30:31], v[24:25] op_sel_hi:[1,0]
    v_pk_mul_f32 v[40:41], v[38:39], v[24:25] op_sel_hi:[1,0]
    v_exp_f32 v32, v32
    v_exp_f32 v33, v33
    v_exp_f32 v40, v40
    v_exp_f32 v41, v41
    v_pk_add_f32 v[32:33], v[32:33], v[24:25] op_sel:[0,1] op_sel_hi:[1,1]
    v_pk_add_f32 v[40:41], v[40:41], v[24:25] op_sel:[0,1] op_sel_hi:[1,1]
    v_rcp_f32 v32, v32
    v_rcp_f32 v33, v33
    v_rcp_f32 v40, v40
    v_rcp_f32 v41, v41
    v_pk_mul_f32 v[30:31], v[30:31], v[32:33]
    v_pk_mul_f32 v[38:39], v[38:39], v[40:41]
    v_cvt_pk_bf16_f32 v34, v30, v31
    v_cvt_pk_bf16_f32 v42, v38, v39
    v_lshlrev_b32 v30, 16, v34
    v_lshlrev_b32 v38, 16, v42
    v_and_b32 v31, 0xffff0000, v34
    v_and_b32 v39, 0xffff0000, v42
    v_pk_fma_f32 v[176:177], v[108:109], v[30:31], v[112:113]
    v_pk_fma_f32 v[178:179], v[110:111], v[38:39], v[114:115]
    buffer_store_dwordx4 v[176:179], v19, s[72:75], 0 offen offset:64 sc1
    v_cvt_pk_bf16_f32 v34, v188, v189
    v_cvt_pk_bf16_f32 v42, v190, v191
    v_lshlrev_b32 v28, 16, v238
    v_lshlrev_b32 v36, 16, v239
    v_and_b32 v29, 0xffff0000, v238
    v_and_b32 v37, 0xffff0000, v239
    v_lshlrev_b32 v188, 16, v34
    v_lshlrev_b32 v190, 16, v42
    v_and_b32 v189, 0xffff0000, v34
    v_and_b32 v191, 0xffff0000, v42
    v_pk_add_f32 v[30:31], v[188:189], v[28:29]
    v_pk_add_f32 v[38:39], v[190:191], v[36:37]
    v_cvt_pk_bf16_f32 v34, v30, v31
    v_cvt_pk_bf16_f32 v42, v38, v39
    v_lshlrev_b32 v30, 16, v34
    v_lshlrev_b32 v38, 16, v42
    v_and_b32 v31, 0xffff0000, v34
    v_and_b32 v39, 0xffff0000, v42
    v_pk_mul_f32 v[32:33], v[30:31], v[24:25] op_sel_hi:[1,0]
    v_pk_mul_f32 v[40:41], v[38:39], v[24:25] op_sel_hi:[1,0]
    v_exp_f32 v32, v32
    v_exp_f32 v33, v33
    v_exp_f32 v40, v40
    v_exp_f32 v41, v41
    v_pk_add_f32 v[32:33], v[32:33], v[24:25] op_sel:[0,1] op_sel_hi:[1,1]
    v_pk_add_f32 v[40:41], v[40:41], v[24:25] op_sel:[0,1] op_sel_hi:[1,1]
    v_rcp_f32 v32, v32
    v_rcp_f32 v33, v33
    v_rcp_f32 v40, v40
    v_rcp_f32 v41, v41
    v_pk_mul_f32 v[30:31], v[30:31], v[32:33]
    v_pk_mul_f32 v[38:39], v[38:39], v[40:41]
    v_cvt_pk_bf16_f32 v34, v30, v31
    v_cvt_pk_bf16_f32 v42, v38, v39
    v_lshlrev_b32 v30, 16, v34
    v_lshlrev_b32 v38, 16, v42
    v_and_b32 v31, 0xffff0000, v34
    v_and_b32 v39, 0xffff0000, v42
    v_pk_fma_f32 v[192:193], v[124:125], v[30:31], v[128:129]
    v_pk_fma_f32 v[194:195], v[126:127], v[38:39], v[130:131]
    buffer_store_dwordx4 v[192:195], v19, s[72:75], 0 offen offset:128 sc1
    v_cvt_pk_bf16_f32 v34, v204, v205
    v_cvt_pk_bf16_f32 v42, v206, v207
    v_lshlrev_b32 v28, 16, v240
    v_lshlrev_b32 v36, 16, v241
    v_and_b32 v29, 0xffff0000, v240
    v_and_b32 v37, 0xffff0000, v241
    v_lshlrev_b32 v204, 16, v34
    v_lshlrev_b32 v206, 16, v42
    v_and_b32 v205, 0xffff0000, v34
    v_and_b32 v207, 0xffff0000, v42
    v_pk_add_f32 v[30:31], v[204:205], v[28:29]
    v_pk_add_f32 v[38:39], v[206:207], v[36:37]
    v_cvt_pk_bf16_f32 v34, v30, v31
    v_cvt_pk_bf16_f32 v42, v38, v39
    v_lshlrev_b32 v30, 16, v34
    v_lshlrev_b32 v38, 16, v42
    v_and_b32 v31, 0xffff0000, v34
    v_and_b32 v39, 0xffff0000, v42
    v_pk_mul_f32 v[32:33], v[30:31], v[24:25] op_sel_hi:[1,0]
    v_pk_mul_f32 v[40:41], v[38:39], v[24:25] op_sel_hi:[1,0]
    v_exp_f32 v32, v32
    v_exp_f32 v33, v33
    v_exp_f32 v40, v40
    v_exp_f32 v41, v41
    v_pk_add_f32 v[32:33], v[32:33], v[24:25] op_sel:[0,1] op_sel_hi:[1,1]
    v_pk_add_f32 v[40:41], v[40:41], v[24:25] op_sel:[0,1] op_sel_hi:[1,1]
    v_rcp_f32 v32, v32
    v_rcp_f32 v33, v33
    v_rcp_f32 v40, v40
    v_rcp_f32 v41, v41
    v_pk_mul_f32 v[30:31], v[30:31], v[32:33]
    v_pk_mul_f32 v[38:39], v[38:39], v[40:41]
    v_cvt_pk_bf16_f32 v34, v30, v31
    v_cvt_pk_bf16_f32 v42, v38, v39
    v_lshlrev_b32 v30, 16, v34
    v_lshlrev_b32 v38, 16, v42
    v_and_b32 v31, 0xffff0000, v34
    v_and_b32 v39, 0xffff0000, v42
    v_pk_fma_f32 v[208:209], v[140:141], v[30:31], v[144:145]
    v_pk_fma_f32 v[210:211], v[142:143], v[38:39], v[146:147]
    buffer_store_dwordx4 v[208:211], v19, s[72:75], 0 offen offset:192 sc1
    s_endpgm
KP_HELPER:
    v_lshrrev_b32 v2, 3, v0
    v_and_b32 v3, 7, v0
    v_and_b32 v4, 15, v0
    v_lshrrev_b32 v5, 4, v0
    s_sub_u32 s40, s2, 224
    s_lshl_b32 s40, s40, 2
    s_add_u32 s40, s40, s3
    v_lshrrev_b32 v6, 1, v2
    v_lshlrev_b32 v6, 1, v6
    v_xor_b32 v6, v6, v3
    v_lshlrev_b32 v6, 4, v6
    s_movk_i32 s68, 896
    v_mad_u32_u24 v6, v2, s68, v6
    v_xor_b32 v8, v3, v2
    v_lshlrev_b32 v8, 4, v8
    v_mad_u32_u24 v8, v2, s68, v8
    s_mul_i32 s69, s3, 20480
    v_lshlrev_b32 v7, 4, v0
    s_waitcnt lgkmcnt(0)
    s_mov_b32 s44, s28
    s_mov_b32 s45, s29
    s_mov_b32 s46, 1605632
    s_mov_b32 s47, 0x00020000
    s_mov_b32 s60, s36
    s_mov_b32 s61, s37
    s_mov_b32 s62, 268435456
    s_mov_b32 s63, 0x00020000
    s_cmp_ge_u32 s40, 49
    s_cbranch_scc1 KPH_W2ONLY
    s_mov_b32 s48, s14
    s_mov_b32 s49, s15
    s_mov_b32 s50, 401408
    s_mov_b32 s51, 0x00020000
    s_mov_b32 s52, s16
    s_mov_b32 s53, s17
    s_mov_b32 s54, 401408
    s_mov_b32 s55, 0x00020000
    s_mov_b32 s70, s40
    s_mul_i32 s71, s70, 1171
    s_lshr_b32 s71, s71, 16
    s_mul_i32 s72, s71, 56
    s_sub_u32 s72, s70, s72
    s_mul_i32 s73, s71, 344064
    s_lshl_b32 s74, s72, 12
    s_add_u32 s73, s73, s74
    s_add_u32 s56, s73, 11010048
    s_mul_i32 s72, s72, 28672
    s_lshl_b32 s71, s71, 7
    s_add_u32 s72, s72, s71
    s_add_u32 m0, s69, 16384
    s_nop 0
    buffer_load_dwordx4 v6, s[44:47], s72 offen lds
    s_add_u32 s72, s72, 6144
    buffer_load_dwordx4 v6, s[44:47], s72 offen offset:1024 lds
    s_add_u32 s72, s72, 6144
    buffer_load_dwordx4 v6, s[44:47], s72 offen offset:2048 lds
    s_add_u32 s72, s72, 6144
    buffer_load_dwordx4 v6, s[44:47], s72 offen offset:3072 lds
    s_mul_i32 s71, s40, 37
    s_lshr_b32 s71, s71, 8
    s_mul_i32 s72, s71, 7
    s_sub_u32 s72, s40, s72
    s_mul_i32 s73, s71, 344064
    s_lshl_b32 s74, s72, 14
    s_add_u32 s73, s73, s74
    s_add_u32 s65, s73, 11239424
    s_mul_i32 s71, s71, 57344
    s_lshl_b32 s72, s72, 7
    s_add_u32 s72, s72, s71
    s_mov_b32 s73, s72
    s_add_u32 m0, s69, 0
    s_nop 0
    buffer_load_dwordx4 v8, s[48:51], s73 offen lds
    s_add_u32 s73, s73, 7168
    s_add_u32 m0, s69, 1024
    s_nop 0
    buffer_load_dwordx4 v8, s[48:51], s73 offen lds
    s_add_u32 s73, s73, 7168
    s_add_u32 m0, s69, 2048
    s_nop 0
    buffer_load_dwordx4 v8, s[48:51], s73 offen lds
    s_add_u32 s73, s73, 7168
    s_add_u32 m0, s69, 3072
    s_nop 0
    buffer_load_dwordx4 v8, s[48:51], s73 offen lds
    s_add_u32 s73, s73, 7168
    s_add_u32 m0, s69, 4096
    s_nop 0
    buffer_load_dwordx4 v8, s[48:51], s73 offen lds
    s_add_u32 s73, s73, 7168
    s_add_u32 m0, s69, 5120
    s_nop 0
    buffer_load_dwordx4 v8, s[48:51], s73 offen lds
    s_add_u32 s73, s73, 7168
    s_add_u32 m0, s69, 6144
    s_nop 0
    buffer_load_dwordx4 v8, s[48:51], s73 offen lds
    s_add_u32 s73, s73, 7168
    s_add_u32 m0, s69, 7168
    s_nop 0
    buffer_load_dwordx4 v8, s[48:51], s73 offen lds
    s_add_u32 s73, s73, 7168
    s_mov_b32 s73, s72
    s_add_u32 m0, s69, 8192
    s_nop 0
    buffer_load_dwordx4 v8, s[52:55], s73 offen lds
    s_add_u32 s73, s73, 7168
    s_add_u32 m0, s69, 9216
    s_nop 0
    buffer_load_dwordx4 v8, s[52:55], s73 offen lds
    s_add_u32 s73, s73, 7168
    s_add_u32 m0, s69, 10240
    s_nop 0
    buffer_load_dwordx4 v8, s[52:55], s73 offen lds
    s_add_u32 s73, s73, 7168
    s_add_u32 m0, s69, 11264
    s_nop 0
    buffer_load_dwordx4 v8, s[52:55], s73 offen lds
    s_add_u32 s73, s73, 7168
    s_add_u32 m0, s69, 12288
    s_nop 0
    buffer_load_dwordx4 v8, s[52:55], s73 offen lds
    s_add_u32 s73, s73, 7168
    s_add_u32 m0, s69, 13312
    s_nop 0
    buffer_load_dwordx4 v8, s[52:55], s73 offen lds
    s_add_u32 s73, s73, 7168
    s_add_u32 m0, s69, 14336
    s_nop 0
    buffer_load_dwordx4 v8, s[52:55], s73 offen lds
    s_add_u32 s73, s73, 7168
    s_add_u32 m0, s69, 15360
    s_nop 0
    buffer_load_dwordx4 v8, s[52:55], s73 offen lds
    s_add_u32 s73, s73, 7168
    v_mov_b32 v11, 0
    global_load_dwordx2 v[224:225], v11, s[34:35] sc1
    v_lshrrev_b32 v9, 2, v4
    v_lshl_add_u32 v9, v5, 2, v9
    v_lshlrev_b32 v9, 7, v9
    v_add_u32 v9, s69, v9
    v_and_b32 v10, 3, v4
    v_lshl_add_u32 v9, v10, 3, v9
    v_and_b32 v10, 1, v5
    v_lshlrev_b32 v10, 1, v10
    v_lshrrev_b32 v11, 3, v4
    v_or_b32 v10, v10, v11
    v_lshlrev_b32 v10, 1, v10
    v_xor_b32 v11, 0, v10
    v_lshl_add_u32 v12, v11, 4, v9
    v_xor_b32 v11, 2, v10
    v_lshl_add_u32 v13, v11, 4, v9
    v_xor_b32 v11, 4, v10
    v_lshl_add_u32 v14, v11, 4, v9
    v_xor_b32 v11, 6, v10
    v_lshl_add_u32 v15, v11, 4, v9
    v_lshlrev_b32 v9, 7, v4
    v_and_b32 v10, 1, v5
    v_lshl_add_u32 v9, v10, 3, v9
    v_add_u32 v9, s69, v9
    v_lshrrev_b32 v10, 1, v5
    v_and_b32 v11, 7, v4
    v_xor_b32 v10, v10, v11
    v_xor_b32 v11, 0, v10
    v_lshl_add_u32 v16, v11, 4, v9
    v_xor_b32 v11, 2, v10
    v_lshl_add_u32 v17, v11, 4, v9
    v_xor_b32 v11, 4, v10
    v_lshl_add_u32 v18, v11, 4, v9
    v_xor_b32 v11, 6, v10
    v_lshl_add_u32 v19, v11, 4, v9
    s_mov_b32 s75, 0x05040100
    s_mov_b32 s76, 0x07060302
    s_waitcnt vmcnt(17)
    ds_read_b64_tr_b16 v[32:33], v12 offset:16384
    ds_read_b64_tr_b16 v[34:35], v12 offset:18432
    ds_read_b64_tr_b16 v[36:37], v13 offset:16384
    ds_read_b64_tr_b16 v[38:39], v13 offset:18432
    ds_read_b64_tr_b16 v[40:41], v14 offset:16384
    ds_read_b64_tr_b16 v[42:43], v14 offset:18432
    ds_read_b64_tr_b16 v[44:45], v15 offset:16384
    ds_read_b64_tr_b16 v[46:47], v15 offset:18432
    s_waitcnt lgkmcnt(0)
    buffer_store_dwordx4 v[32:35], v7, s[60:63], s56 offen offset:0 sc1
    buffer_store_dwordx4 v[36:39], v7, s[60:63], s56 offen offset:1024 sc1
    buffer_store_dwordx4 v[40:43], v7, s[60:63], s56 offen offset:2048 sc1
    buffer_store_dwordx4 v[44:47], v7, s[60:63], s56 offen offset:3072 sc1
    s_waitcnt vmcnt(5)
    ds_read_b64 v[48:49], v16 offset:0
    ds_read_b64 v[50:51], v16 offset:8192
    s_waitcnt lgkmcnt(0)
    v_perm_b32 v64, v50, v48, s75
    v_perm_b32 v65, v50, v48, s76
    v_perm_b32 v66, v51, v49, s75
    v_perm_b32 v67, v51, v49, s76
    buffer_store_dwordx4 v[64:67], v7, s[60:63], s65 offen offset:0 sc1
    ds_read_b64 v[52:53], v16 offset:2048
    ds_read_b64 v[54:55], v16 offset:10240
    s_waitcnt lgkmcnt(0)
    s_nop 0
    v_perm_b32 v68, v54, v52, s75
    v_perm_b32 v69, v54, v52, s76
    v_perm_b32 v70, v55, v53, s75
    v_perm_b32 v71, v55, v53, s76
    buffer_store_dwordx4 v[68:71], v7, s[60:63], s65 offen offset:1024 sc1
    ds_read_b64 v[48:49], v16 offset:4096
    ds_read_b64 v[50:51], v16 offset:12288
    s_waitcnt lgkmcnt(0)
    s_nop 0
    v_perm_b32 v72, v50, v48, s75
    v_perm_b32 v73, v50, v48, s76
    v_perm_b32 v74, v51, v49, s75
    v_perm_b32 v75, v51, v49, s76
    buffer_store_dwordx4 v[72:75], v7, s[60:63], s65 offen offset:2048 sc1
    ds_read_b64 v[52:53], v16 offset:6144
    ds_read_b64 v[54:55], v16 offset:14336
    s_waitcnt lgkmcnt(0)
    s_nop 0
    v_perm_b32 v76, v54, v52, s75
    v_perm_b32 v77, v54, v52, s76
    v_perm_b32 v78, v55, v53, s75
    v_perm_b32 v79, v55, v53, s76
    buffer_store_dwordx4 v[76:79], v7, s[60:63], s65 offen offset:3072 sc1
    s_add_u32 s65, s65, 4096
    ds_read_b64 v[48:49], v17 offset:0
    ds_read_b64 v[50:51], v17 offset:8192
    s_waitcnt lgkmcnt(0)
    s_nop 0
    v_perm_b32 v80, v50, v48, s75
    v_perm_b32 v81, v50, v48, s76
    v_perm_b32 v82, v51, v49, s75
    v_perm_b32 v83, v51, v49, s76
    buffer_store_dwordx4 v[80:83], v7, s[60:63], s65 offen offset:0 sc1
    ds_read_b64 v[52:53], v17 offset:2048
    ds_read_b64 v[54:55], v17 offset:10240
    s_waitcnt lgkmcnt(0)
    s_nop 0
    v_perm_b32 v84, v54, v52, s75
    v_perm_b32 v85, v54, v52, s76
    v_perm_b32 v86, v55, v53, s75
    v_perm_b32 v87, v55, v53, s76
    buffer_store_dwordx4 v[84:87], v7, s[60:63], s65 offen offset:1024 sc1
    ds_read_b64 v[48:49], v17 offset:4096
    ds_read_b64 v[50:51], v17 offset:12288
    s_waitcnt lgkmcnt(0)
    s_nop 0
    v_perm_b32 v88, v50, v48, s75
    v_perm_b32 v89, v50, v48, s76
    v_perm_b32 v90, v51, v49, s75
    v_perm_b32 v91, v51, v49, s76
    buffer_store_dwordx4 v[88:91], v7, s[60:63], s65 offen offset:2048 sc1
    ds_read_b64 v[52:53], v17 offset:6144
    ds_read_b64 v[54:55], v17 offset:14336
    s_waitcnt lgkmcnt(0)
    s_nop 0
    v_perm_b32 v92, v54, v52, s75
    v_perm_b32 v93, v54, v52, s76
    v_perm_b32 v94, v55, v53, s75
    v_perm_b32 v95, v55, v53, s76
    buffer_store_dwordx4 v[92:95], v7, s[60:63], s65 offen offset:3072 sc1
    s_add_u32 s65, s65, 4096
    ds_read_b64 v[48:49], v18 offset:0
    ds_read_b64 v[50:51], v18 offset:8192
    s_waitcnt lgkmcnt(0)
    s_nop 0
    v_perm_b32 v96, v50, v48, s75
    v_perm_b32 v97, v50, v48, s76
    v_perm_b32 v98, v51, v49, s75
    v_perm_b32 v99, v51, v49, s76
    buffer_store_dwordx4 v[96:99], v7, s[60:63], s65 offen offset:0 sc1
    ds_read_b64 v[52:53], v18 offset:2048
    ds_read_b64 v[54:55], v18 offset:10240
    s_waitcnt lgkmcnt(0)
    s_nop 0
    v_perm_b32 v100, v54, v52, s75
    v_perm_b32 v101, v54, v52, s76
    v_perm_b32 v102, v55, v53, s75
    v_perm_b32 v103, v55, v53, s76
    buffer_store_dwordx4 v[100:103], v7, s[60:63], s65 offen offset:1024 sc1
    ds_read_b64 v[48:49], v18 offset:4096
    ds_read_b64 v[50:51], v18 offset:12288
    s_waitcnt lgkmcnt(0)
    s_nop 0
    v_perm_b32 v104, v50, v48, s75
    v_perm_b32 v105, v50, v48, s76
    v_perm_b32 v106, v51, v49, s75
    v_perm_b32 v107, v51, v49, s76
    buffer_store_dwordx4 v[104:107], v7, s[60:63], s65 offen offset:2048 sc1
    ds_read_b64 v[52:53], v18 offset:6144
    ds_read_b64 v[54:55], v18 offset:14336
    s_waitcnt lgkmcnt(0)
    s_nop 0
    v_perm_b32 v108, v54, v52, s75
    v_perm_b32 v109, v54, v52, s76
    v_perm_b32 v110, v55, v53, s75
    v_perm_b32 v111, v55, v53, s76
    buffer_store_dwordx4 v[108:111], v7, s[60:63], s65 offen offset:3072 sc1
    s_add_u32 s65, s65, 4096
    ds_read_b64 v[48:49], v19 offset:0
    ds_read_b64 v[50:51], v19 offset:8192
    s_waitcnt lgkmcnt(0)
    s_nop 0
    v_perm_b32 v112, v50, v48, s75
    v_perm_b32 v113, v50, v48, s76
    v_perm_b32 v114, v51, v49, s75
    v_perm_b32 v115, v51, v49, s76
    buffer_store_dwordx4 v[112:115], v7, s[60:63], s65 offen offset:0 sc1
    ds_read_b64 v[52:53], v19 offset:2048
    ds_read_b64 v[54:55], v19 offset:10240
    s_waitcnt lgkmcnt(0)
    s_nop 0
    v_perm_b32 v116, v54, v52, s75
    v_perm_b32 v117, v54, v52, s76
    v_perm_b32 v118, v55, v53, s75
    v_perm_b32 v119, v55, v53, s76
    buffer_store_dwordx4 v[116:119], v7, s[60:63], s65 offen offset:1024 sc1
    ds_read_b64 v[48:49], v19 offset:4096
    ds_read_b64 v[50:51], v19 offset:12288
    s_waitcnt lgkmcnt(0)
    s_nop 0
    v_perm_b32 v120, v50, v48, s75
    v_perm_b32 v121, v50, v48, s76
    v_perm_b32 v122, v51, v49, s75
    v_perm_b32 v123, v51, v49, s76
    buffer_store_dwordx4 v[120:123], v7, s[60:63], s65 offen offset:2048 sc1
    ds_read_b64 v[52:53], v19 offset:6144
    ds_read_b64 v[54:55], v19 offset:14336
    s_waitcnt lgkmcnt(0)
    s_nop 0
    v_perm_b32 v124, v54, v52, s75
    v_perm_b32 v125, v54, v52, s76
    v_perm_b32 v126, v55, v53, s75
    v_perm_b32 v127, v55, v53, s76
    buffer_store_dwordx4 v[124:127], v7, s[60:63], s65 offen offset:3072 sc1
    s_add_u32 s65, s65, 4096
    s_branch KPH_DONE
KPH_W2ONLY:
    s_sub_u32 s41, s40, 0
    s_add_u32 s70, s41, 0
    s_mul_i32 s71, s70, 1171
    s_lshr_b32 s71, s71, 16
    s_mul_i32 s72, s71, 56
    s_sub_u32 s72, s70, s72
    s_mul_i32 s73, s71, 344064
    s_lshl_b32 s74, s72, 12
    s_add_u32 s73, s73, s74
    s_add_u32 s56, s73, 11010048
    s_mul_i32 s72, s72, 28672
    s_lshl_b32 s71, s71, 7
    s_add_u32 s72, s72, s71
    s_add_u32 m0, s69, 0
    s_nop 0
    buffer_load_dwordx4 v6, s[44:47], s72 offen lds
    s_add_u32 s72, s72, 6144
    buffer_load_dwordx4 v6, s[44:47], s72 offen offset:1024 lds
    s_add_u32 s72, s72, 6144
    buffer_load_dwordx4 v6, s[44:47], s72 offen offset:2048 lds
    s_add_u32 s72, s72, 6144
    buffer_load_dwordx4 v6, s[44:47], s72 offen offset:3072 lds
    s_add_u32 s70, s41, 79
    s_mul_i32 s71, s70, 1171
    s_lshr_b32 s71, s71, 16
    s_mul_i32 s72, s71, 56
    s_sub_u32 s72, s70, s72
    s_mul_i32 s73, s71, 344064
    s_lshl_b32 s74, s72, 12
    s_add_u32 s73, s73, s74
    s_add_u32 s57, s73, 11010048
    s_mul_i32 s72, s72, 28672
    s_lshl_b32 s71, s71, 7
    s_add_u32 s72, s72, s71
    s_add_u32 m0, s69, 4096
    s_nop 0
    buffer_load_dwordx4 v6, s[44:47], s72 offen lds
    s_add_u32 s72, s72, 6144
    buffer_load_dwordx4 v6, s[44:47], s72 offen offset:1024 lds
    s_add_u32 s72, s72, 6144
    buffer_load_dwordx4 v6, s[44:47], s72 offen offset:2048 lds
    s_add_u32 s72, s72, 6144
    buffer_load_dwordx4 v6, s[44:47], s72 offen offset:3072 lds
    s_add_u32 s70, s41, 158
    s_mul_i32 s71, s70, 1171
    s_lshr_b32 s71, s71, 16
    s_mul_i32 s72, s71, 56
    s_sub_u32 s72, s70, s72
    s_mul_i32 s73, s71, 344064
    s_lshl_b32 s74, s72, 12
    s_add_u32 s73, s73, s74
    s_add_u32 s58, s73, 11010048
    s_mul_i32 s72, s72, 28672
    s_lshl_b32 s71, s71, 7
    s_add_u32 s72, s72, s71
    s_add_u32 m0, s69, 8192
    s_nop 0
    buffer_load_dwordx4 v6, s[44:47], s72 offen lds
    s_add_u32 s72, s72, 6144
    buffer_load_dwordx4 v6, s[44:47], s72 offen offset:1024 lds
    s_add_u32 s72, s72, 6144
    buffer_load_dwordx4 v6, s[44:47], s72 offen offset:2048 lds
    s_add_u32 s72, s72, 6144
    buffer_load_dwordx4 v6, s[44:47], s72 offen offset:3072 lds
    s_add_u32 s70, s41, 237
    s_mul_i32 s71, s70, 1171
    s_lshr_b32 s71, s71, 16
    s_mul_i32 s72, s71, 56
    s_sub_u32 s72, s70, s72
    s_mul_i32 s73, s71, 344064
    s_lshl_b32 s74, s72, 12
    s_add_u32 s73, s73, s74
    s_add_u32 s59, s73, 11010048
    s_mul_i32 s72, s72, 28672
    s_lshl_b32 s71, s71, 7
    s_add_u32 s72, s72, s71
    s_add_u32 m0, s69, 12288
    s_nop 0
    buffer_load_dwordx4 v6, s[44:47], s72 offen lds
    s_add_u32 s72, s72, 6144
    buffer_load_dwordx4 v6, s[44:47], s72 offen offset:1024 lds
    s_add_u32 s72, s72, 6144
    buffer_load_dwordx4 v6, s[44:47], s72 offen offset:2048 lds
    s_add_u32 s72, s72, 6144
    buffer_load_dwordx4 v6, s[44:47], s72 offen offset:3072 lds
    s_cmp_ge_u32 s41, 76
    s_cbranch_scc1 KPH_NO4
    s_add_u32 s70, s41, 316
    s_mul_i32 s71, s70, 1171
    s_lshr_b32 s71, s71, 16
    s_mul_i32 s72, s71, 56
    s_sub_u32 s72, s70, s72
    s_mul_i32 s73, s71, 344064
    s_lshl_b32 s74, s72, 12
    s_add_u32 s73, s73, s74
    s_add_u32 s64, s73, 11010048
    s_mul_i32 s72, s72, 28672
    s_lshl_b32 s71, s71, 7
    s_add_u32 s72, s72, s71
    s_add_u32 m0, s69, 16384
    s_nop 0
    buffer_load_dwordx4 v6, s[44:47], s72 offen lds
    s_add_u32 s72, s72, 6144
    buffer_load_dwordx4 v6, s[44:47], s72 offen offset:1024 lds
    s_add_u32 s72, s72, 6144
    buffer_load_dwordx4 v6, s[44:47], s72 offen offset:2048 lds
    s_add_u32 s72, s72, 6144
    buffer_load_dwordx4 v6, s[44:47], s72 offen offset:3072 lds
KPH_NO4:
    v_mov_b32 v11, 0
    global_load_dwordx2 v[224:225], v11, s[34:35] sc1
    v_lshrrev_b32 v9, 2, v4
    v_lshl_add_u32 v9, v5, 2, v9
    v_lshlrev_b32 v9, 7, v9
    v_add_u32 v9, s69, v9
    v_and_b32 v10, 3, v4
    v_lshl_add_u32 v9, v10, 3, v9
    v_and_b32 v10, 1, v5
    v_lshlrev_b32 v10, 1, v10
    v_lshrrev_b32 v11, 3, v4
    v_or_b32 v10, v10, v11
    v_lshlrev_b32 v10, 1, v10
    v_xor_b32 v11, 0, v10
    v_lshl_add_u32 v12, v11, 4, v9
    v_xor_b32 v11, 2, v10
    v_lshl_add_u32 v13, v11, 4, v9
    v_xor_b32 v11, 4, v10
    v_lshl_add_u32 v14, v11, 4, v9
    v_xor_b32 v11, 6, v10
    v_lshl_add_u32 v15, v11, 4, v9
    s_waitcnt vmcnt(13)
    ds_read_b64_tr_b16 v[32:33], v12 offset:0
    ds_read_b64_tr_b16 v[34:35], v12 offset:2048
    ds_read_b64_tr_b16 v[36:37], v13 offset:0
    ds_read_b64_tr_b16 v[38:39], v13 offset:2048
    ds_read_b64_tr_b16 v[40:41], v14 offset:0
    ds_read_b64_tr_b16 v[42:43], v14 offset:2048
    ds_read_b64_tr_b16 v[44:45], v15 offset:0
    ds_read_b64_tr_b16 v[46:47], v15 offset:2048
    s_waitcnt lgkmcnt(0)
    buffer_store_dwordx4 v[32:35], v7, s[60:63], s56 offen offset:0 sc1
    buffer_store_dwordx4 v[36:39], v7, s[60:63], s56 offen offset:1024 sc1
    buffer_store_dwordx4 v[40:43], v7, s[60:63], s56 offen offset:2048 sc1
    buffer_store_dwordx4 v[44:47], v7, s[60:63], s56 offen offset:3072 sc1
    s_waitcnt vmcnt(13)
    ds_read_b64_tr_b16 v[48:49], v12 offset:4096
    ds_read_b64_tr_b16 v[50:51], v12 offset:6144
    ds_read_b64_tr_b16 v[52:53], v13 offset:4096
    ds_read_b64_tr_b16 v[54:55], v13 offset:6144
    ds_read_b64_tr_b16 v[56:57], v14 offset:4096
    ds_read_b64_tr_b16 v[58:59], v14 offset:6144
    ds_read_b64_tr_b16 v[60:61], v15 offset:4096
    ds_read_b64_tr_b16 v[62:63], v15 offset:6144
    s_waitcnt lgkmcnt(0)
    buffer_store_dwordx4 v[48:51], v7, s[60:63], s57 offen offset:0 sc1
    buffer_store_dwordx4 v[52:55], v7, s[60:63], s57 offen offset:1024 sc1
    buffer_store_dwordx4 v[56:59], v7, s[60:63], s57 offen offset:2048 sc1
    buffer_store_dwordx4 v[60:63], v7, s[60:63], s57 offen offset:3072 sc1
    s_waitcnt vmcnt(13)
    ds_read_b64_tr_b16 v[64:65], v12 offset:8192
    ds_read_b64_tr_b16 v[66:67], v12 offset:10240
    ds_read_b64_tr_b16 v[68:69], v13 offset:8192
    ds_read_b64_tr_b16 v[70:71], v13 offset:10240
    ds_read_b64_tr_b16 v[72:73], v14 offset:8192
    ds_read_b64_tr_b16 v[74:75], v14 offset:10240
    ds_read_b64_tr_b16 v[76:77], v15 offset:8192
    ds_read_b64_tr_b16 v[78:79], v15 offset:10240
    s_waitcnt lgkmcnt(0)
    buffer_store_dwordx4 v[64:67], v7, s[60:63], s58 offen offset:0 sc1
    buffer_store_dwordx4 v[68:71], v7, s[60:63], s58 offen offset:1024 sc1
    buffer_store_dwordx4 v[72:75], v7, s[60:63], s58 offen offset:2048 sc1
    buffer_store_dwordx4 v[76:79], v7, s[60:63], s58 offen offset:3072 sc1
    s_waitcnt vmcnt(13)
    ds_read_b64_tr_b16 v[80:81], v12 offset:12288
    ds_read_b64_tr_b16 v[82:83], v12 offset:14336
    ds_read_b64_tr_b16 v[84:85], v13 offset:12288
    ds_read_b64_tr_b16 v[86:87], v13 offset:14336
    ds_read_b64_tr_b16 v[88:89], v14 offset:12288
    ds_read_b64_tr_b16 v[90:91], v14 offset:14336
    ds_read_b64_tr_b16 v[92:93], v15 offset:12288
    ds_read_b64_tr_b16 v[94:95], v15 offset:14336
    s_waitcnt lgkmcnt(0)
    buffer_store_dwordx4 v[80:83], v7, s[60:63], s59 offen offset:0 sc1
    buffer_store_dwordx4 v[84:87], v7, s[60:63], s59 offen offset:1024 sc1
    buffer_store_dwordx4 v[88:91], v7, s[60:63], s59 offen offset:2048 sc1
    buffer_store_dwordx4 v[92:95], v7, s[60:63], s59 offen offset:3072 sc1
    s_cmp_ge_u32 s41, 76
    s_cbranch_scc1 KPH_DONE
    s_waitcnt vmcnt(16)
    ds_read_b64_tr_b16 v[96:97], v12 offset:16384
    ds_read_b64_tr_b16 v[98:99], v12 offset:18432
    ds_read_b64_tr_b16 v[100:101], v13 offset:16384
    ds_read_b64_tr_b16 v[102:103], v13 offset:18432
    ds_read_b64_tr_b16 v[104:105], v14 offset:16384
    ds_read_b64_tr_b16 v[106:107], v14 offset:18432
    ds_read_b64_tr_b16 v[108:109], v15 offset:16384
    ds_read_b64_tr_b16 v[110:111], v15 offset:18432
    s_waitcnt lgkmcnt(0)
    buffer_store_dwordx4 v[96:99], v7, s[60:63], s64 offen offset:0 sc1
    buffer_store_dwordx4 v[100:103], v7, s[60:63], s64 offen offset:1024 sc1
    buffer_store_dwordx4 v[104:107], v7, s[60:63], s64 offen offset:2048 sc1
    buffer_store_dwordx4 v[108:111], v7, s[60:63], s64 offen offset:3072 sc1
KPH_DONE:
    s_waitcnt vmcnt(0)
    v_cmp_ne_u32 vcc, 0, v224
    s_cbranch_vccnz KPH_NONCE_OK
    s_mov_b32 s82, 262144
KPH_NONCE_LOOP:
    s_sub_u32 s82, s82, 1
    s_cmp_eq_u32 s82, 0
    s_cbranch_scc1 KPH_NONCE_OK
    s_sleep 1
    v_mov_b32 v9, 0
    global_load_dwordx2 v[224:225], v9, s[34:35] sc1
    s_waitcnt vmcnt(0)
    v_cmp_ne_u32 vcc, 0, v224
    s_cbranch_vccz KPH_NONCE_LOOP
KPH_NONCE_OK:
    s_lshl_b32 s70, s40, 3
    s_add_u32 s70, s70, 13680640
    v_mov_b32 v9, 0
    s_mov_b64 exec, 1
    buffer_store_dwordx2 v[224:225], v9, s[60:63], s70 offen sc1
    s_mov_b64 exec, -1
    s_endpgm
KP_EXIT:
    s_endpgm
.section .rodata,"a"
.p2align 6
.amdhsa_kernel recurrent_scan__ssm_conv_s5__mixer_channel_mlp__prompt_kernel
  .amdhsa_next_free_vgpr 512
  .amdhsa_next_free_sgpr 102
  .amdhsa_accum_offset 256
  .amdhsa_group_segment_fixed_size 0
  .amdhsa_kernarg_size 136
  .amdhsa_user_sgpr_count 2
  .amdhsa_user_sgpr_kernarg_segment_ptr 1
  .amdhsa_system_sgpr_workgroup_id_x 1
  .amdhsa_float_denorm_mode_32 3
.end_amdhsa_kernel
```
